```python
import torch

def _softmax(x, axis=-1):
    return torch.softmax(x, dim=axis)

def _gelu(x):
    return torch.nn.functional.gelu(x, approximate='tanh')

def _silu(x):
    return torch.nn.functional.silu(x)

def _sigmoid(x):
    return torch.sigmoid(x)

def _layernorm(x, axis=-1, eps=1e-05):
    m = x.mean(dim=axis, keepdim=True)
    v = x.var(dim=axis, keepdim=True, unbiased=False)
    return (x - m) / torch.sqrt(v + eps)

def _scatter_add(tgt, idx, src, axis=0):
    return tgt.clone().index_add_(axis, idx, src)

def _segment_sum(src, seg, n):
    out = torch.zeros((n,) + src.shape[1:], dtype=src.dtype)
    return out.index_add_(0, seg, src)

def _pad(x, pw):
    flat = tuple((v for pair in reversed(pw) for v in pair))
    return torch.nn.functional.pad(x, flat)
kernel_name = 'standalone__video_timesformer__vision'

def setup_inputs():

    _w = lambda a: (lambda t: t.to(torch.bfloat16) if t.is_floating_point() else t)(torch.as_tensor(a))
    T = 8
    p = 16
    HW = 512 // p * p
    N = (HW // p) ** 2
    C = 192
    return {'x': _w((lambda *s: torch.randn(*s, dtype=torch.bfloat16) * 0.1)(1, T, N, C)), 'wqkv_t': _w((lambda *s: torch.randn(*s, dtype=torch.bfloat16) * 0.1)(C, 3 * C)), 'wo_t': _w((lambda *s: torch.randn(*s, dtype=torch.bfloat16) * 0.1)(C, C)), 'wqkv_s': _w((lambda *s: torch.randn(*s, dtype=torch.bfloat16) * 0.1)(C, 3 * C)), 'wo_s': _w((lambda *s: torch.randn(*s, dtype=torch.bfloat16) * 0.05)(C, C))}

def reference(x, wqkv_t, wo_t, wqkv_s, wo_s):
    B, T, N, C = x.shape
    scale = C ** (-0.5)
    xt = (lambda x, *d: x.permute(*d))(x, 0, 2, 1, 3).reshape(B * N, T, C)
    h = _layernorm(xt, axis=-1)
    qkv = h @ wqkv_t
    q, k, v = (qkv[..., :C].clone(), qkv[..., C:2 * C].clone(), qkv[..., 2 * C:].clone())
    a = _softmax(torch.einsum('btc,bsc->bts', q, k) * scale, axis=-1)
    xt = xt + torch.einsum('bts,bsc->btc', a, v) @ wo_t
    x1 = (lambda x, *d: x.permute(*d))(xt.reshape(B, N, T, C), 0, 2, 1, 3)
    xs = x1.reshape(B * T, N, C)
    h = _layernorm(xs, axis=-1)
    qkv = h @ wqkv_s
    q, k, v = (qkv[..., :C].clone(), qkv[..., C:2 * C].clone(), qkv[..., 2 * C:].clone())
    a = _softmax(torch.einsum('bnc,bmc->bnm', q, k) * scale, axis=-1)
    xs = xs + torch.einsum('bnm,bmc->bnc', a, v) @ wo_s
    return xs.reshape(B, T, N, C)
```

```asm
; @launch kernel=k1_kernel grid=(256,1,1) block=(512,1,1) lds=163840
; @launch kernel=k2_kernel grid=(256,1,1) block=(512,1,1) lds=163840
.amdgcn_target "amdgcn-amd-amdhsa--gfx950"
.text
.p2align 12
.globl k1_kernel
.p2align 8
.type k1_kernel,@function
k1_kernel:
  s_cmp_ge_u32 s2, 256
  s_cbranch_scc1 k1_exit
  s_load_dwordx16 s[16:31], s[0:1], 0
  v_and_b32 v1, 63, v0
  v_lshrrev_b32 v2, 6, v0
  s_nop 0
  v_readfirstlane_b32 s3, v2
  s_lshl_b32 s4, s2, 2
  s_cmp_ge_u32 s3, 4
  s_cbranch_scc1 k1_loader
  s_mov_b64 exec, 0
  s_cmp_eq_u32 s3, 0
  s_cbranch_scc1 .Lk1_pad0
  s_cmp_eq_u32 s3, 1
  s_cbranch_scc1 .Lk1_pad1
  s_cmp_eq_u32 s3, 2
  s_cbranch_scc1 .Lk1_pad2
  s_cmp_eq_u32 s3, 3
  s_cbranch_scc1 .Lk1_pad3
  s_branch k1_retc
k1_loader:
  s_sub_u32 s7, s3, 4
  v_lshrrev_b32 v12, 3, v1
  s_lshl_b32 s8, s7, 3
  v_add_u32 v12, s8, v12
  v_bfe_u32 v13, v1, 4, 1
  v_lshlrev_b32 v13, 1, v13
  s_and_b32 s8, s7, 1
  s_lshl_b32 s8, s8, 2
  v_or_b32 v13, s8, v13
  v_and_b32 v14, 7, v1
  v_xor_b32 v14, v14, v13
  v_lshlrev_b32_e64 v14, 4, v14
  v_mul_u32_u24 v15, 1152, v12
  v_add_u32_e64 v4, v15, v14
  v_mul_u32_u24 v15, 384, v12
  v_add_u32 v5, v15, v14
  s_lshl_b32 s12, s7, 10
  s_lshr_b32 s8, s2, 3
  s_lshl_b32 s9, s8, 2
  s_and_b32 s10, s2, 3
  s_add_u32 s9, s9, s10
  s_lshl_b32 s10, s7, 7
  s_add_u32 s15, s9, s10
  s_bitcmp1_b32 s2, 2
  s_cselect_b32 s15, 999, s15
  v_lshlrev_b32 v20, 6, v1
  s_waitcnt lgkmcnt(0)
  s_mov_b32 s36, s18
  s_mov_b32 s37, s19
  s_mov_b32 s38, 221184
  s_mov_b32 s39, 0x00020000
  s_mov_b32 s40, s20
  s_mov_b32 s41, s21
  s_mov_b32 s42, 73728
  s_mov_b32 s43, 0x00020000
  s_mov_b32 s44, s30
  s_mov_b32 s45, s31
  s_mov_b32 s46, 268435456
  s_mov_b32 s47, 0x00020000
  s_cmp_eq_u32 s7, 2
  s_cbranch_scc1 k1_pf_o
  s_mul_i32 s8, s8, 6912
  s_lshl_b32 s9, s7, 12
  s_add_u32 s8, s8, s9
  s_cmp_eq_u32 s7, 3
  s_cbranch_scc1 k1_pf_done
  buffer_load_dword v21, v20, s[36:39], s8 offen
  s_branch k1_pf_done
k1_pf_o:
  s_mul_i32 s8, s8, 2304
  buffer_load_dword v21, v20, s[40:43], s8 offen
k1_pf_done:
  v_lshlrev_b32 v22, 4, v1
  s_barrier
  s_mov_b32 s13, 0
  s_add_u32 m0, s12, 0
  s_nop 0
  buffer_load_dwordx4 v4, s[36:39], s13 offen lds
  s_mov_b32 s13, 36864
  s_add_u32 m0, s12, 4096
  s_nop 0
  buffer_load_dwordx4 v4, s[36:39], s13 offen lds
  s_mov_b32 s13, 73728
  s_add_u32 m0, s12, 8192
  s_nop 0
  buffer_load_dwordx4 v4, s[36:39], s13 offen lds
  s_mov_b32 s13, 110592
  s_add_u32 m0, s12, 12288
  s_nop 0
  buffer_load_dwordx4 v4, s[36:39], s13 offen lds
  s_mov_b32 s13, 147456
  s_add_u32 m0, s12, 16384
  s_nop 0
  buffer_load_dwordx4 v4, s[36:39], s13 offen lds
  s_mov_b32 s13, 184320
  s_add_u32 m0, s12, 20480
  s_nop 0
  buffer_load_dwordx4 v4, s[36:39], s13 offen lds
  s_mov_b32 s13, 384
  s_add_u32 m0, s12, 24576
  s_nop 0
  buffer_load_dwordx4 v4, s[36:39], s13 offen lds
  s_mov_b32 s13, 37248
  s_add_u32 m0, s12, 28672
  s_nop 0
  buffer_load_dwordx4 v4, s[36:39], s13 offen lds
  s_barrier
  s_mov_b32 s13, 74112
  s_add_u32 m0, s12, 32768
  s_nop 0
  buffer_load_dwordx4 v4, s[36:39], s13 offen lds
  s_mov_b32 s13, 110976
  s_add_u32 m0, s12, 36864
  s_nop 0
  buffer_load_dwordx4 v4, s[36:39], s13 offen lds
  s_mov_b32 s13, 147840
  s_add_u32 m0, s12, 40960
  s_nop 0
  buffer_load_dwordx4 v4, s[36:39], s13 offen lds
  s_mov_b32 s13, 184704
  s_add_u32 m0, s12, 45056
  s_nop 0
  buffer_load_dwordx4 v4, s[36:39], s13 offen lds
  s_mov_b32 s13, 128
  s_add_u32 m0, s12, 49152
  s_nop 0
  buffer_load_dwordx4 v4, s[36:39], s13 offen lds
  s_mov_b32 s13, 36992
  s_add_u32 m0, s12, 53248
  s_nop 0
  buffer_load_dwordx4 v4, s[36:39], s13 offen lds
  s_mov_b32 s13, 73856
  s_add_u32 m0, s12, 57344
  s_nop 0
  buffer_load_dwordx4 v4, s[36:39], s13 offen lds
  s_mov_b32 s13, 110720
  s_add_u32 m0, s12, 61440
  s_nop 0
  buffer_load_dwordx4 v4, s[36:39], s13 offen lds
  s_waitcnt vmcnt(10)
  s_barrier
  s_mov_b32 s13, 147584
  s_add_u32 m0, s12, 65536
  s_nop 0
  buffer_load_dwordx4 v4, s[36:39], s13 offen lds
  s_mov_b32 s13, 184448
  s_add_u32 m0, s12, 69632
  s_nop 0
  buffer_load_dwordx4 v4, s[36:39], s13 offen lds
  s_mov_b32 s13, 512
  s_add_u32 m0, s12, 73728
  s_nop 0
  buffer_load_dwordx4 v4, s[36:39], s13 offen lds
  s_mov_b32 s13, 37376
  s_add_u32 m0, s12, 77824
  s_nop 0
  buffer_load_dwordx4 v4, s[36:39], s13 offen lds
  s_mov_b32 s13, 74240
  s_add_u32 m0, s12, 81920
  s_nop 0
  buffer_load_dwordx4 v4, s[36:39], s13 offen lds
  s_mov_b32 s13, 111104
  s_add_u32 m0, s12, 86016
  s_nop 0
  buffer_load_dwordx4 v4, s[36:39], s13 offen lds
  s_waitcnt vmcnt(10)
  s_barrier
  s_mov_b32 s13, 147968
  s_add_u32 m0, s12, 90112
  s_nop 0
  buffer_load_dwordx4 v4, s[36:39], s13 offen lds
  s_mov_b32 s13, 184832
.Lk1_pad0:
  s_cbranch_execz .Lk1_pad4
  s_add_u32 m0, s12, 94208
  s_nop 0
  buffer_load_dwordx4 v4, s[36:39], s13 offen lds
  s_mov_b32 s13, 256
  s_add_u32 m0, s12, 98304
  s_nop 0
  buffer_load_dwordx4 v4, s[36:39], s13 offen lds
  s_mov_b32 s13, 37120
  s_add_u32 m0, s12, 102400
  s_nop 0
  buffer_load_dwordx4 v4, s[36:39], s13 offen lds
  s_mov_b32 s13, 73984
  s_add_u32 m0, s12, 106496
  s_nop 0
  buffer_load_dwordx4 v4, s[36:39], s13 offen lds
  s_mov_b32 s13, 110848
  s_add_u32 m0, s12, 110592
  s_nop 0
  buffer_load_dwordx4 v4, s[36:39], s13 offen lds
  s_waitcnt vmcnt(10)
  s_barrier
  s_mov_b32 s13, 147712
  s_add_u32 m0, s12, 114688
  s_nop 0
  buffer_load_dwordx4 v4, s[36:39], s13 offen lds
  s_mov_b32 s13, 184576
  s_add_u32 m0, s12, 118784
  s_nop 0
  buffer_load_dwordx4 v4, s[36:39], s13 offen lds
  s_mov_b32 s13, 640
  s_add_u32 m0, s12, 122880
  s_nop 0
  buffer_load_dwordx4 v4, s[36:39], s13 offen lds
  s_mov_b32 s13, 37504
  s_add_u32 m0, s12, 126976
  s_nop 0
  buffer_load_dwordx4 v4, s[36:39], s13 offen lds
  s_mov_b32 s13, 74368
  s_add_u32 m0, s12, 131072
  s_nop 0
  buffer_load_dwordx4 v4, s[36:39], s13 offen lds
  s_mov_b32 s13, 111232
  s_add_u32 m0, s12, 135168
  s_nop 0
  buffer_load_dwordx4 v4, s[36:39], s13 offen lds
  s_waitcnt vmcnt(10)
  s_barrier
  s_mov_b32 s13, 148096
  s_add_u32 m0, s12, 139264
  s_nop 0
  buffer_load_dwordx4 v4, s[36:39], s13 offen lds
  s_mov_b32 s13, 184960
  s_add_u32 m0, s12, 143360
  s_nop 0
  buffer_load_dwordx4 v4, s[36:39], s13 offen lds
  s_mov_b32 s13, 768
  s_add_u32 m0, s12, 0
  s_nop 0
  buffer_load_dwordx4 v4, s[36:39], s13 offen lds
  s_mov_b32 s13, 37632
  s_add_u32 m0, s12, 4096
  s_nop 0
  buffer_load_dwordx4 v4, s[36:39], s13 offen lds
  s_mov_b32 s13, 74496
  s_add_u32 m0, s12, 8192
  s_nop 0
  buffer_load_dwordx4 v4, s[36:39], s13 offen lds
  s_mov_b32 s13, 111360
  s_add_u32 m0, s12, 12288
  s_nop 0
  buffer_load_dwordx4 v4, s[36:39], s13 offen lds
  s_waitcnt vmcnt(10)
  s_barrier
  s_mov_b32 s13, 148224
  s_add_u32 m0, s12, 16384
  s_nop 0
  buffer_load_dwordx4 v4, s[36:39], s13 offen lds
  s_mov_b32 s13, 185088
  s_add_u32 m0, s12, 20480
  s_nop 0
  buffer_load_dwordx4 v4, s[36:39], s13 offen lds
  s_mov_b32 s13, 896
  s_add_u32 m0, s12, 24576
  s_nop 0
  buffer_load_dwordx4 v4, s[36:39], s13 offen lds
  s_mov_b32 s13, 37760
  s_add_u32 m0, s12, 28672
  s_nop 0
  buffer_load_dwordx4 v4, s[36:39], s13 offen lds
  s_mov_b32 s13, 74624
  s_add_u32 m0, s12, 32768
  s_nop 0
  buffer_load_dwordx4 v4, s[36:39], s13 offen lds
  s_mov_b32 s13, 111488
  s_add_u32 m0, s12, 36864
  s_nop 0
  buffer_load_dwordx4 v4, s[36:39], s13 offen lds
  s_waitcnt vmcnt(10)
  s_barrier
  s_mov_b32 s13, 148352
  s_add_u32 m0, s12, 40960
  s_nop 0
  buffer_load_dwordx4 v4, s[36:39], s13 offen lds
  s_mov_b32 s13, 185216
  s_add_u32 m0, s12, 45056
  s_nop 0
  buffer_load_dwordx4 v4, s[36:39], s13 offen lds
  s_mov_b32 s13, 1024
  s_add_u32 m0, s12, 49152
  s_nop 0
  buffer_load_dwordx4 v4, s[36:39], s13 offen lds
  s_mov_b32 s13, 37888
  s_add_u32 m0, s12, 53248
  s_nop 0
  buffer_load_dwordx4 v4, s[36:39], s13 offen lds
  s_mov_b32 s13, 74752
  s_add_u32 m0, s12, 57344
  s_nop 0
  buffer_load_dwordx4 v4, s[36:39], s13 offen lds
  s_mov_b32 s13, 111616
  s_add_u32 m0, s12, 61440
  s_nop 0
  buffer_load_dwordx4 v4, s[36:39], s13 offen lds
  s_waitcnt vmcnt(10)
  s_barrier
  s_mov_b32 s13, 148480
  s_add_u32 m0, s12, 65536
  s_nop 0
  buffer_load_dwordx4 v4, s[36:39], s13 offen lds
  s_mov_b32 s13, 185344
  s_add_u32 m0, s12, 69632
  s_nop 0
  buffer_load_dwordx4 v4, s[36:39], s13 offen lds
  s_mov_b32 s13, 0
  s_add_u32 m0, s12, 73728
  s_nop 0
  buffer_load_dwordx4 v5, s[40:43], s13 offen lds
  s_mov_b32 s13, 12288
  s_add_u32 m0, s12, 77824
  s_nop 0
  buffer_load_dwordx4 v5, s[40:43], s13 offen lds
  s_mov_b32 s13, 24576
  s_add_u32 m0, s12, 81920
  s_nop 0
  buffer_load_dwordx4 v5, s[40:43], s13 offen lds
  s_mov_b32 s13, 36864
  s_add_u32 m0, s12, 86016
  s_nop 0
  buffer_load_dwordx4 v5, s[40:43], s13 offen lds
  s_waitcnt vmcnt(10)
  s_barrier
  s_mov_b32 s13, 49152
.Lk1_pad1:
  s_cbranch_execz .Lk1_pad5
  s_add_u32 m0, s12, 90112
  s_nop 0
  buffer_load_dwordx4 v5, s[40:43], s13 offen lds
  s_mov_b32 s13, 61440
  s_add_u32 m0, s12, 94208
  s_nop 0
  buffer_load_dwordx4 v5, s[40:43], s13 offen lds
  s_mov_b32 s13, 128
  s_add_u32 m0, s12, 98304
  s_nop 0
  buffer_load_dwordx4 v5, s[40:43], s13 offen lds
  s_mov_b32 s13, 12416
  s_add_u32 m0, s12, 102400
  s_nop 0
  buffer_load_dwordx4 v5, s[40:43], s13 offen lds
  s_mov_b32 s13, 24704
  s_add_u32 m0, s12, 106496
  s_nop 0
  buffer_load_dwordx4 v5, s[40:43], s13 offen lds
  s_mov_b32 s13, 36992
  s_add_u32 m0, s12, 110592
  s_nop 0
  buffer_load_dwordx4 v5, s[40:43], s13 offen lds
  s_waitcnt vmcnt(10)
  s_barrier
  s_mov_b32 s13, 49280
  s_add_u32 m0, s12, 114688
  s_nop 0
  buffer_load_dwordx4 v5, s[40:43], s13 offen lds
  s_mov_b32 s13, 61568
  s_add_u32 m0, s12, 118784
  s_nop 0
  buffer_load_dwordx4 v5, s[40:43], s13 offen lds
  s_mov_b32 s13, 256
  s_add_u32 m0, s12, 122880
  s_nop 0
  buffer_load_dwordx4 v5, s[40:43], s13 offen lds
  s_mov_b32 s13, 12544
  s_add_u32 m0, s12, 126976
  s_nop 0
  buffer_load_dwordx4 v5, s[40:43], s13 offen lds
  s_mov_b32 s13, 24832
  s_add_u32 m0, s12, 131072
  s_nop 0
  buffer_load_dwordx4 v5, s[40:43], s13 offen lds
  s_mov_b32 s13, 37120
  s_add_u32 m0, s12, 135168
  s_nop 0
  buffer_load_dwordx4 v5, s[40:43], s13 offen lds
  s_waitcnt vmcnt(10)
  s_barrier
  s_mov_b32 s13, 49408
  s_add_u32 m0, s12, 139264
  s_nop 0
  buffer_load_dwordx4 v5, s[40:43], s13 offen lds
  s_mov_b32 s13, 61696
  s_add_u32 m0, s12, 143360
  s_nop 0
  buffer_load_dwordx4 v5, s[40:43], s13 offen lds
  s_cmp_lt_u32 s15, 72
  s_cbranch_scc1 k1_fl0
  s_cmp_lt_u32 s15, 144
  s_cbranch_scc1 k1_fl1
  s_waitcnt vmcnt(6)
  s_barrier
  s_waitcnt vmcnt(0)
  s_barrier
k1_fbret:
  s_barrier
  s_cmp_ge_u32 s15, 144
  s_cbranch_scc1 k1_ldone
  buffer_store_dwordx4 v[136:139], v22, s[44:47], s62 offen sc0 sc1
k1_ldone:
  s_cmp_lg_u32 s2, 200
  s_cbranch_scc1 k1_notab
  s_cmp_lg_u32 s7, 1
  s_cbranch_scc1 k1_notab
  v_add_u32 v12, 1, v1
  v_lshlrev_b32 v13, 2, v1
  s_mov_b32 s8, 3358720
  buffer_store_dword v12, v13, s[44:47], s8 offen sc0 sc1
k1_notab:
  s_mov_b64 exec, 0
  s_cmp_eq_u32 s7, 1
  s_cbranch_scc1 .Lk2_apad0
  s_cmp_eq_u32 s7, 2
  s_cbranch_scc1 .Lk2_pad1
  s_cmp_eq_u32 s7, 3
  s_cbranch_scc1 .Lk2_pad2
  s_endpgm
k1_warm0:
  s_branch .Lk2_pad0
k1_exit:
  s_endpgm
k1_retc:
  s_mov_b64 exec, -1
  v_lshrrev_b32 v2, 3, v1
  v_and_b32 v3, 7, v1
  s_lshl_b32 s7, s3, 2
  v_add_u32_e64 v240, 0, v1
  v_mul_u32_u24 v241, 171, v240
  v_lshrrev_b32 v241, 12, v241
  v_mul_u32_u24 v242, 24, v241
  v_sub_u32 v240, v240, v242
  v_lshrrev_b32 v242, 1, v241
  v_add_u32 v242, s7, v242
  v_and_b32 v242, 7, v242
  v_xor_b32_e64 v240, v240, v242
  v_mul_u32_u24 v236, 393216, v241
  v_lshl_add_u32 v236, v240, 4, v236
  v_add_u32_e64 v240, 64, v1
  v_mul_u32_u24 v241, 171, v240
  v_lshrrev_b32 v241, 12, v241
  v_mul_u32_u24 v242, 24, v241
  v_sub_u32 v240, v240, v242
  v_lshrrev_b32 v242, 1, v241
  v_add_u32 v242, s7, v242
  v_and_b32 v242, 7, v242
  v_xor_b32_e64 v240, v240, v242
  v_mul_u32_u24 v237, 393216, v241
  v_lshl_add_u32 v237, v240, 4, v237
  v_add_u32 v240, 128, v1
  v_mul_u32_u24 v241, 171, v240
  v_lshrrev_b32 v241, 12, v241
  v_mul_u32_u24 v242, 24, v241
  v_sub_u32 v240, v240, v242
  v_lshrrev_b32 v242, 1, v241
  v_add_u32 v242, s7, v242
  v_and_b32 v242, 7, v242
  v_xor_b32_e64 v240, v240, v242
  v_mul_u32_u24 v238, 393216, v241
  v_lshl_add_u32 v238, v240, 4, v238
  s_add_u32 s5, s4, s3
  s_mul_i32 s6, s5, 384
  s_mul_i32 s8, s3, 3072
  s_add_u32 s8, s8, 147456
  s_waitcnt lgkmcnt(0)
  s_mov_b32 s32, s16
  s_mov_b32 s33, s17
  s_mov_b32 s34, 3145728
  s_mov_b32 s35, 0x00020000
  s_add_u32 m0, s8, 0
  s_nop 0
  buffer_load_dwordx4 v236, s[32:35], s6 offen lds
  s_add_u32 m0, s8, 1024
  s_nop 0
  buffer_load_dwordx4 v237, s[32:35], s6 offen lds
  s_add_u32 m0, s8, 2048
  s_nop 0
  buffer_load_dwordx4 v238, s[32:35], s6 offen lds
  s_barrier
  s_mov_b32 s44, s30
  s_mov_b32 s45, s31
  s_mov_b32 s46, 268435456
  s_mov_b32 s47, 0x00020000
  v_lshrrev_b32 v249, 4, v1
  v_and_b32_e64 v250, 15, v1
  v_bfe_u32 v240, v1, 2, 2
  v_lshl_add_u32 v240, v249, 3, v240
  v_lshlrev_b32 v240, 7, v240
  v_and_b32 v241, 1, v1
  v_lshl_add_u32 v240, v241, 3, v240
  v_bfe_u32 v241, v1, 3, 1
  v_bfe_u32 v242, v1, 4, 1
  v_lshlrev_b32_e64 v241, 1, v241
  v_lshl_or_b32 v241, v242, 2, v241
  v_bfe_u32 v242, v1, 1, 1
  s_lshl_b32 s7, s3, 1
  v_add_u32 v242, s7, v242
  v_xor_b32_e64 v242, v242, v241
  v_lshl_add_u32 v220, v242, 4, v240
  v_add_u32 v221, 49152, v220
  v_add_u32 v222, 98304, v220
.Lk1_pad2:
  s_cbranch_execz .Lk1_pad6
  v_bfe_u32 v251, v1, 1, 3
  v_mul_u32_u24 v240, 384, v250
  v_add_u32 v240, 147456, v240
  v_xor_b32 v241, v251, v249
  v_lshl_add_u32 v223, v241, 4, v240
  v_xor_b32_e64 v241, 4, v241
  v_lshl_add_u32 v224, v241, 4, v240
  v_lshrrev_b32 v241, 5, v1
  v_add_u32 v241, s7, v241
  v_xor_b32_e64 v242, v241, v251
  v_lshl_add_u32 v225, v242, 4, v240
  v_bfe_u32 v242, v1, 4, 1
  v_lshl_add_u32 v225, v242, 3, v225
  v_bfe_u32 v243, v1, 3, 1
  v_lshl_add_u32 v243, v242, 1, v243
  s_and_b32 s8, s4, 31
  v_add_u32 v244, s8, v243
  v_and_b32 v245, 3, v241
  v_lshlrev_b32 v245, 2, v245
  v_xor_b32 v244, v244, v245
  v_lshlrev_b32 v244, 4, v244
  v_lshl_add_u32 v244, v241, 9, v244
  v_and_b32_e64 v245, 7, v1
  v_mul_u32_u24 v232, 393216, v245
  v_add_u32 v232, v232, v244
  v_lshlrev_b32 v235, 13, v245
  v_lshl_add_u32 v235, v243, 3, v235
  s_lshl_b32 s8, s3, 3
  v_add_u32 v241, s8, v2
  v_bfe_u32 v242, v241, 1, 3
  v_xor_b32_e64 v242, v242, v3
  v_mul_u32_u24 v243, 384, v241
  v_lshl_add_u32 v226, v242, 4, v243
  v_add_u32 v226, 147456, v226
  v_min_u32 v242, 3, v3
  v_lshlrev_b32 v242, 2, v242
  v_lshl_add_u32 v229, v241, 4, v242
  v_lshlrev_b32_e64 v242, 2, v241
  v_add_u32 v243, 512, v242
  v_cmp_eq_u32 vcc, 3, v3
  s_nop 1
  v_cndmask_b32_e64 v229, v229, v243, vcc
  v_add_u32 v243, 640, v242
  v_cmp_eq_u32 vcc, 4, v3
  s_nop 1
  v_cndmask_b32_e64 v229, v229, v243, vcc
  v_add_u32 v229, 159744, v229
  v_lshlrev_b32_e64 v230, 4, v250
  v_add_u32 v230, 159744, v230
  v_lshlrev_b32_e64 v2, 4, v249
  v_add_u32 v2, 160256, v2
  v_lshlrev_b32_e64 v228, 4, v1
  v_add_u32 v228, 159744, v228
  s_lshl_b32 s8, s3, 10
  v_add_u32 v227, s8, v228
  v_lshlrev_b32_e64 v234, 4, v250
  v_add_u32 v234, 159744, v234
  v_lshl_add_u32 v233, v249, 8, v234
  s_lshl_b32 s8, s3, 2
  v_add_u32 v233, s8, v233
  s_mov_b32 s10, 0x00FF00FF
  s_mov_b32 s11, 0xFF00FF00
  s_mov_b64 vcc, s[10:11]
  v_cndmask_b32 v231, 0, -1, vcc
  v_lshrrev_b32 v244, 4, v1
  v_bfe_u32 v245, v1, 3, 1
  s_and_b32 s8, s3, 1
  s_lshl_b32 s8, s8, 1
  v_add_u32_e64 v245, s8, v245
  v_bfe_u32 v246, v1, 1, 2
  v_cmp_eq_u32 vcc, v244, v245
  s_nop 1
  v_cndmask_b32 v246, 7, v246, vcc
  v_and_b32 v247, 1, v1
  v_lshlrev_b32_e64 v247, 4, v247
  v_mov_b32 v248, 0x3f80
  v_lshlrev_b32 v247, v247, v248
  v_cmp_eq_u32 vcc, 0, v246
  s_nop 1
  v_cndmask_b32 v204, 0, v247, vcc
  v_cmp_eq_u32 vcc, 1, v246
  s_nop 1
  v_cndmask_b32 v205, 0, v247, vcc
  v_cmp_eq_u32 vcc, 2, v246
  s_nop 1
  v_cndmask_b32 v206, 0, v247, vcc
  v_cmp_eq_u32 vcc, 3, v246
  s_nop 1
  v_cndmask_b32_e64 v207, 0, v247, vcc
  v_mov_b32 v216, 0x3f803f80
  v_mov_b32 v217, 0x3f803f80
  v_mov_b32 v218, 0x3f803f80
  v_mov_b32 v219, 0x3f803f80
  s_mov_b32 s56, 0x09090909
  s_mov_b32 s57, 0x09090909
  s_mov_b32 s58, 0x12121212
  s_mov_b32 s59, 0x12121212
  s_waitcnt vmcnt(0)
  s_barrier
  ds_read_b128 v[4:7], v226 offset:0
  ds_read_b128 v[8:11], v226 offset:128
  ds_read_b128 v[12:15], v226 offset:256
  ds_read_b128 v[64:67], v223 offset:0
  ds_read_b128 v[88:91], v223 offset:6144
  ds_read_b128 v[68:71], v224 offset:0
  ds_read_b128 v[92:95], v224 offset:6144
  ds_read_b128 v[72:75], v223 offset:128
  ds_read_b128 v[96:99], v223 offset:6272
  ds_read_b128 v[76:79], v224 offset:128
  ds_read_b128 v[100:103], v224 offset:6272
  ds_read_b128 v[80:83], v223 offset:256
  ds_read_b128 v[104:107], v223 offset:6400
  ds_read_b128 v[84:87], v224 offset:256
  ds_read_b128 v[108:111], v224 offset:6400
  s_waitcnt lgkmcnt(14)
  v_lshlrev_b32 v16, 16, v4
  v_and_b32 v17, 0xffff0000, v4
  v_lshlrev_b32_e64 v18, 16, v5
  v_and_b32 v19, 0xffff0000, v5
  v_lshlrev_b32_e64 v20, 16, v6
  v_and_b32 v21, 0xffff0000, v6
  v_lshlrev_b32_e64 v22, 16, v7
  v_and_b32 v23, 0xffff0000, v7
  s_waitcnt lgkmcnt(13)
  v_lshlrev_b32 v24, 16, v8
  v_and_b32 v25, 0xffff0000, v8
  v_lshlrev_b32_e64 v26, 16, v9
  v_and_b32 v27, 0xffff0000, v9
  v_lshlrev_b32_e64 v28, 16, v10
  v_and_b32 v29, 0xffff0000, v10
  v_lshlrev_b32_e64 v30, 16, v11
  v_and_b32 v31, 0xffff0000, v11
  s_waitcnt lgkmcnt(12)
  v_lshlrev_b32 v32, 16, v12
  v_and_b32 v33, 0xffff0000, v12
  v_lshlrev_b32_e64 v34, 16, v13
  v_and_b32 v35, 0xffff0000, v13
  v_lshlrev_b32_e64 v36, 16, v14
  v_and_b32 v37, 0xffff0000, v14
  v_lshlrev_b32_e64 v38, 16, v15
  v_and_b32 v39, 0xffff0000, v15
  v_pk_add_f32 v[236:237], v[16:17], v[18:19]
  v_pk_add_f32 v[238:239], v[20:21], v[22:23]
  v_pk_add_f32 v[236:237], v[236:237], v[24:25]
  v_pk_add_f32 v[238:239], v[238:239], v[26:27]
  v_pk_add_f32 v[236:237], v[236:237], v[28:29]
  v_pk_add_f32 v[238:239], v[238:239], v[30:31]
  v_pk_add_f32 v[236:237], v[236:237], v[32:33]
  v_pk_add_f32 v[238:239], v[238:239], v[34:35]
  v_pk_add_f32 v[236:237], v[236:237], v[36:37]
  v_pk_add_f32 v[238:239], v[238:239], v[38:39]
  v_pk_add_f32 v[236:237], v[236:237], v[238:239]
  v_add_f32 v236, v236, v237
  s_nop 1
.Lk1_pad3:
  s_cbranch_execz .Lk1_pad7
  v_add_f32_dpp v236, v236, v236 quad_perm:[1,0,3,2] row_mask:0xf bank_mask:0xf
  s_nop 1
  v_add_f32_dpp v236, v236, v236 quad_perm:[2,3,0,1] row_mask:0xf bank_mask:0xf
  s_nop 1
  v_add_f32_dpp v236, v236, v236 row_half_mirror row_mask:0xf bank_mask:0xf
  v_mul_f32 v236, 0x3baaaaab, v236
  v_sub_f32 v238, 0, v236
  v_sub_f32_e64 v239, 0, v236
  v_pk_add_f32 v[40:41], v[16:17], v[238:239]
  v_pk_add_f32 v[42:43], v[18:19], v[238:239]
  v_pk_add_f32 v[44:45], v[20:21], v[238:239]
  v_pk_add_f32 v[46:47], v[22:23], v[238:239]
  v_pk_add_f32 v[48:49], v[24:25], v[238:239]
  v_pk_add_f32 v[50:51], v[26:27], v[238:239]
  v_pk_add_f32 v[52:53], v[28:29], v[238:239]
  v_pk_add_f32 v[54:55], v[30:31], v[238:239]
  v_pk_add_f32 v[56:57], v[32:33], v[238:239]
  v_pk_add_f32 v[58:59], v[34:35], v[238:239]
  v_pk_add_f32 v[60:61], v[36:37], v[238:239]
  v_pk_add_f32 v[62:63], v[38:39], v[238:239]
  v_pk_mul_f32 v[240:241], v[40:41], v[40:41]
  v_pk_mul_f32 v[242:243], v[42:43], v[42:43]
  v_pk_fma_f32 v[240:241], v[44:45], v[44:45], v[240:241]
  v_pk_fma_f32 v[242:243], v[46:47], v[46:47], v[242:243]
  v_pk_fma_f32 v[240:241], v[48:49], v[48:49], v[240:241]
  v_pk_fma_f32 v[242:243], v[50:51], v[50:51], v[242:243]
  v_pk_fma_f32 v[240:241], v[52:53], v[52:53], v[240:241]
  v_pk_fma_f32 v[242:243], v[54:55], v[54:55], v[242:243]
  v_pk_fma_f32 v[240:241], v[56:57], v[56:57], v[240:241]
  v_pk_fma_f32 v[242:243], v[58:59], v[58:59], v[242:243]
  v_pk_fma_f32 v[240:241], v[60:61], v[60:61], v[240:241]
  v_pk_fma_f32 v[242:243], v[62:63], v[62:63], v[242:243]
  v_pk_add_f32 v[240:241], v[240:241], v[242:243]
  v_add_f32 v240, v240, v241
  s_nop 1
  v_add_f32_dpp v240, v240, v240 quad_perm:[1,0,3,2] row_mask:0xf bank_mask:0xf
  s_nop 1
  v_add_f32_dpp v240, v240, v240 quad_perm:[2,3,0,1] row_mask:0xf bank_mask:0xf
  s_nop 1
  v_add_f32_dpp v240, v240, v240 row_half_mirror row_mask:0xf bank_mask:0xf
  v_mov_b32 v241, 0x3727c5ac
  v_fmac_f32 v241, 0x3baaaaab, v240
  v_rsq_f32 v238, v241
  s_nop 0
  v_mov_b32_e64 v239, v238
  v_mul_f32_e64 v237, -v236, v238
  v_cndmask_b32 v240, v236, v238, s[56:57]
  v_cndmask_b32 v240, v240, v237, s[58:59]
  ds_write_b32 v229, v240
  s_waitcnt lgkmcnt(0)
  s_barrier
  ds_read_b128 v[12:15], v230 offset:0
  ds_read_b128 v[60:63], v230 offset:256
  ds_read_b64_tr_b16 v[112:113], v220 offset:0
  ds_read_b64_tr_b16 v[114:115], v220 offset:512
  ds_read_b64_tr_b16 v[116:117], v220 offset:4096
  ds_read_b64_tr_b16 v[118:119], v220 offset:4608
  ds_read_b64_tr_b16 v[120:121], v220 offset:8192
  ds_read_b64_tr_b16 v[122:123], v220 offset:8704
  ds_read_b64_tr_b16 v[124:125], v220 offset:12288
  ds_read_b64_tr_b16 v[126:127], v220 offset:12800
  ds_read_b64_tr_b16 v[128:129], v220 offset:16384
  ds_read_b64_tr_b16 v[130:131], v220 offset:16896
  ds_read_b64_tr_b16 v[132:133], v220 offset:20480
  ds_read_b64_tr_b16 v[134:135], v220 offset:20992
  ds_read_b128 v[4:7], v2 offset:0
  ds_read_b128 v[252:255], v2 offset:128
  ds_read_b128 v[8:11], v2 offset:64
  ds_read_b128 v[240:243], v2 offset:192
  s_cmp_ge_u32 s3, 2
  s_cbranch_scc1 k1_selhi
  v_mfma_f32_16x16x32_bf16 v[16:19], v[204:207], v[64:67], 0
  v_mfma_f32_16x16x32_bf16 v[20:23], v[204:207], v[88:91], 0
  v_mfma_f32_16x16x32_bf16 v[24:27], v[204:207], v[72:75], 0
  v_mfma_f32_16x16x32_bf16 v[28:31], v[204:207], v[96:99], 0
  v_mfma_f32_16x16x32_bf16 v[32:35], v[204:207], v[80:83], 0
  v_mfma_f32_16x16x32_bf16 v[36:39], v[204:207], v[104:107], 0
  s_branch k1_seljoin
k1_selhi:
  v_mfma_f32_16x16x32_bf16 v[16:19], v[204:207], v[68:71], 0
  v_mfma_f32_16x16x32_bf16 v[20:23], v[204:207], v[92:95], 0
  v_mfma_f32_16x16x32_bf16 v[24:27], v[204:207], v[76:79], 0
  v_mfma_f32_16x16x32_bf16 v[28:31], v[204:207], v[100:103], 0
  v_mfma_f32_16x16x32_bf16 v[32:35], v[204:207], v[84:87], 0
  v_mfma_f32_16x16x32_bf16 v[36:39], v[204:207], v[108:111], 0
k1_seljoin:
  s_waitcnt lgkmcnt(15)
  v_pk_add_f32 v[16:17], v[16:17], v[14:15] op_sel:[0,0] op_sel_hi:[1,0] neg_lo:[0,1] neg_hi:[0,1]
  v_pk_add_f32 v[18:19], v[18:19], v[14:15] op_sel:[0,0] op_sel_hi:[1,0] neg_lo:[0,1] neg_hi:[0,1]
  v_pk_add_f32 v[20:21], v[20:21], v[62:63] op_sel:[0,0] op_sel_hi:[1,0] neg_lo:[0,1] neg_hi:[0,1]
  v_pk_add_f32 v[22:23], v[22:23], v[62:63] op_sel:[0,0] op_sel_hi:[1,0] neg_lo:[0,1] neg_hi:[0,1]
  v_pk_add_f32 v[24:25], v[24:25], v[14:15] op_sel:[0,0] op_sel_hi:[1,0] neg_lo:[0,1] neg_hi:[0,1]
  v_pk_add_f32 v[26:27], v[26:27], v[14:15] op_sel:[0,0] op_sel_hi:[1,0] neg_lo:[0,1] neg_hi:[0,1]
  v_pk_add_f32 v[28:29], v[28:29], v[62:63] op_sel:[0,0] op_sel_hi:[1,0] neg_lo:[0,1] neg_hi:[0,1]
  v_pk_add_f32 v[30:31], v[30:31], v[62:63] op_sel:[0,0] op_sel_hi:[1,0] neg_lo:[0,1] neg_hi:[0,1]
  v_pk_add_f32 v[32:33], v[32:33], v[14:15] op_sel:[0,0] op_sel_hi:[1,0] neg_lo:[0,1] neg_hi:[0,1]
  v_pk_add_f32 v[34:35], v[34:35], v[14:15] op_sel:[0,0] op_sel_hi:[1,0] neg_lo:[0,1] neg_hi:[0,1]
  v_pk_add_f32 v[36:37], v[36:37], v[62:63] op_sel:[0,0] op_sel_hi:[1,0] neg_lo:[0,1] neg_hi:[0,1]
  v_pk_add_f32 v[38:39], v[38:39], v[62:63] op_sel:[0,0] op_sel_hi:[1,0] neg_lo:[0,1] neg_hi:[0,1]
  s_waitcnt lgkmcnt(0)
  s_barrier
  v_mfma_f32_16x16x32_bf16 v[160:163], v[112:115], v[64:67], 0
  v_mfma_f32_16x16x32_bf16 v[164:167], v[112:115], v[88:91], 0
  v_mfma_f32_16x16x32_bf16 v[244:247], v[112:115], v[216:219], 0
  ds_read_b64_tr_b16 v[136:137], v220 offset:24576
  ds_read_b64_tr_b16 v[138:139], v220 offset:25088
  v_mfma_f32_16x16x32_bf16 v[160:163], v[116:119], v[68:71], v[160:163]
  v_mfma_f32_16x16x32_bf16 v[164:167], v[116:119], v[92:95], v[164:167]
  v_mfma_f32_16x16x32_bf16 v[244:247], v[116:119], v[216:219], v[244:247]
  ds_read_b64_tr_b16 v[140:141], v220 offset:28672
  ds_read_b64_tr_b16 v[142:143], v220 offset:29184
  v_mfma_f32_16x16x32_bf16 v[160:163], v[120:123], v[72:75], v[160:163]
  v_mfma_f32_16x16x32_bf16 v[164:167], v[120:123], v[96:99], v[164:167]
  v_mfma_f32_16x16x32_bf16 v[244:247], v[120:123], v[216:219], v[244:247]
  ds_read_b64_tr_b16 v[144:145], v220 offset:32768
  ds_read_b64_tr_b16 v[146:147], v220 offset:33280
  v_mfma_f32_16x16x32_bf16 v[160:163], v[124:127], v[76:79], v[160:163]
  v_mfma_f32_16x16x32_bf16 v[164:167], v[124:127], v[100:103], v[164:167]
  v_mfma_f32_16x16x32_bf16 v[244:247], v[124:127], v[216:219], v[244:247]
  ds_read_b64_tr_b16 v[148:149], v220 offset:36864
  ds_read_b64_tr_b16 v[150:151], v220 offset:37376
  v_mfma_f32_16x16x32_bf16 v[160:163], v[128:131], v[80:83], v[160:163]
  v_mfma_f32_16x16x32_bf16 v[164:167], v[128:131], v[104:107], v[164:167]
  v_mfma_f32_16x16x32_bf16 v[244:247], v[128:131], v[216:219], v[244:247]
  ds_read_b64_tr_b16 v[152:153], v220 offset:40960
  ds_read_b64_tr_b16 v[154:155], v220 offset:41472
  v_mfma_f32_16x16x32_bf16 v[160:163], v[132:135], v[84:87], v[160:163]
  v_mfma_f32_16x16x32_bf16 v[164:167], v[132:135], v[108:111], v[164:167]
  v_mfma_f32_16x16x32_bf16 v[244:247], v[132:135], v[216:219], v[244:247]
  ds_read_b64_tr_b16 v[156:157], v220 offset:45056
  ds_read_b64_tr_b16 v[158:159], v220 offset:45568
  v_pk_mul_f32 v[160:161], v[160:161], v[12:13] op_sel:[0,0] op_sel_hi:[1,0]
  v_pk_mul_f32 v[162:163], v[162:163], v[12:13] op_sel:[0,0] op_sel_hi:[1,0]
  v_pk_mul_f32 v[164:165], v[164:165], v[60:61] op_sel:[0,0] op_sel_hi:[1,0]
  v_pk_mul_f32 v[166:167], v[166:167], v[60:61] op_sel:[0,0] op_sel_hi:[1,0]
  s_nop 1
  s_nop 0
  v_pk_fma_f32 v[160:161], v[244:245], v[12:13], v[160:161] op_sel:[0,1,0] op_sel_hi:[1,1,1]
  v_pk_fma_f32 v[162:163], v[246:247], v[12:13], v[162:163] op_sel:[0,1,0] op_sel_hi:[1,1,1]
.Lk1_pad4:
  s_cbranch_execz .Lk1_pad8
  s_nop 0
  v_pk_fma_f32 v[164:165], v[244:245], v[60:61], v[164:165] op_sel:[0,1,0] op_sel_hi:[1,1,1]
  v_pk_fma_f32 v[166:167], v[246:247], v[60:61], v[166:167] op_sel:[0,1,0] op_sel_hi:[1,1,1]
  v_cvt_pk_bf16_f32 v176, v160, v161
  v_cvt_pk_bf16_f32 v177, v162, v163
  v_cvt_pk_bf16_f32 v178, v164, v165
  v_cvt_pk_bf16_f32 v179, v166, v167
  s_waitcnt lgkmcnt(0)
  s_barrier
  v_mfma_f32_16x16x32_bf16 v[168:171], v[136:139], v[64:67], 0
  v_mfma_f32_16x16x32_bf16 v[172:175], v[136:139], v[88:91], 0
  v_mfma_f32_16x16x32_bf16 v[248:251], v[136:139], v[216:219], 0
  ds_read_b64_tr_b16 v[112:113], v221 offset:0
  ds_read_b64_tr_b16 v[114:115], v221 offset:512
  v_mfma_f32_16x16x32_bf16 v[168:171], v[140:143], v[68:71], v[168:171]
  v_mfma_f32_16x16x32_bf16 v[172:175], v[140:143], v[92:95], v[172:175]
  v_mfma_f32_16x16x32_bf16 v[248:251], v[140:143], v[216:219], v[248:251]
  ds_read_b64_tr_b16 v[116:117], v221 offset:4096
  ds_read_b64_tr_b16 v[118:119], v221 offset:4608
  v_mfma_f32_16x16x32_bf16 v[168:171], v[144:147], v[72:75], v[168:171]
  v_mfma_f32_16x16x32_bf16 v[172:175], v[144:147], v[96:99], v[172:175]
  v_mfma_f32_16x16x32_bf16 v[248:251], v[144:147], v[216:219], v[248:251]
  ds_read_b64_tr_b16 v[120:121], v221 offset:8192
  ds_read_b64_tr_b16 v[122:123], v221 offset:8704
  v_mfma_f32_16x16x32_bf16 v[168:171], v[148:151], v[76:79], v[168:171]
  v_mfma_f32_16x16x32_bf16 v[172:175], v[148:151], v[100:103], v[172:175]
  v_mfma_f32_16x16x32_bf16 v[248:251], v[148:151], v[216:219], v[248:251]
  ds_read_b64_tr_b16 v[124:125], v221 offset:12288
  ds_read_b64_tr_b16 v[126:127], v221 offset:12800
  v_mfma_f32_16x16x32_bf16 v[168:171], v[152:155], v[80:83], v[168:171]
  v_mfma_f32_16x16x32_bf16 v[172:175], v[152:155], v[104:107], v[172:175]
  v_mfma_f32_16x16x32_bf16 v[248:251], v[152:155], v[216:219], v[248:251]
  ds_read_b64_tr_b16 v[128:129], v221 offset:16384
  ds_read_b64_tr_b16 v[130:131], v221 offset:16896
  v_mfma_f32_16x16x32_bf16 v[168:171], v[156:159], v[84:87], v[168:171]
  v_mfma_f32_16x16x32_bf16 v[172:175], v[156:159], v[108:111], v[172:175]
  v_mfma_f32_16x16x32_bf16 v[248:251], v[156:159], v[216:219], v[248:251]
  ds_read_b64_tr_b16 v[132:133], v221 offset:20480
  ds_read_b64_tr_b16 v[134:135], v221 offset:20992
  v_pk_mul_f32 v[168:169], v[168:169], v[12:13] op_sel:[0,0] op_sel_hi:[1,0]
  v_pk_mul_f32 v[170:171], v[170:171], v[12:13] op_sel:[0,0] op_sel_hi:[1,0]
  v_pk_mul_f32 v[172:173], v[172:173], v[60:61] op_sel:[0,0] op_sel_hi:[1,0]
  v_pk_mul_f32 v[174:175], v[174:175], v[60:61] op_sel:[0,0] op_sel_hi:[1,0]
  s_nop 1
  s_nop 0
  v_pk_fma_f32 v[168:169], v[248:249], v[12:13], v[168:169] op_sel:[0,1,0] op_sel_hi:[1,1,1]
  v_pk_fma_f32 v[170:171], v[250:251], v[12:13], v[170:171] op_sel:[0,1,0] op_sel_hi:[1,1,1]
  v_pk_fma_f32 v[172:173], v[248:249], v[60:61], v[172:173] op_sel:[0,1,0] op_sel_hi:[1,1,1]
  v_pk_fma_f32 v[174:175], v[250:251], v[60:61], v[174:175] op_sel:[0,1,0] op_sel_hi:[1,1,1]
  v_cvt_pk_bf16_f32 v180, v168, v169
  v_cvt_pk_bf16_f32 v181, v170, v171
  v_cvt_pk_bf16_f32 v182, v172, v173
  v_cvt_pk_bf16_f32 v183, v174, v175
  v_mfma_f32_16x16x16_bf16 v[184:187], v[180:181], v[176:177], 0
  s_nop 0
  v_mfma_f32_16x16x16_bf16 v[188:191], v[182:183], v[178:179], 0
  s_waitcnt lgkmcnt(0)
  s_barrier
  v_mfma_f32_16x16x32_bf16 v[160:163], v[112:115], v[64:67], 0
  v_mfma_f32_16x16x32_bf16 v[164:167], v[112:115], v[88:91], 0
  v_mfma_f32_16x16x32_bf16 v[244:247], v[112:115], v[216:219], 0
  ds_read_b64_tr_b16 v[136:137], v221 offset:24576
  ds_read_b64_tr_b16 v[138:139], v221 offset:25088
  v_mfma_f32_16x16x32_bf16 v[160:163], v[116:119], v[68:71], v[160:163]
  v_mfma_f32_16x16x32_bf16 v[164:167], v[116:119], v[92:95], v[164:167]
  v_mfma_f32_16x16x32_bf16 v[244:247], v[116:119], v[216:219], v[244:247]
  ds_read_b64_tr_b16 v[140:141], v221 offset:28672
  ds_read_b64_tr_b16 v[142:143], v221 offset:29184
  v_mfma_f32_16x16x32_bf16 v[160:163], v[120:123], v[72:75], v[160:163]
  v_mfma_f32_16x16x32_bf16 v[164:167], v[120:123], v[96:99], v[164:167]
  v_mfma_f32_16x16x32_bf16 v[244:247], v[120:123], v[216:219], v[244:247]
  ds_read_b64_tr_b16 v[144:145], v221 offset:32768
  ds_read_b64_tr_b16 v[146:147], v221 offset:33280
  v_mfma_f32_16x16x32_bf16 v[160:163], v[124:127], v[76:79], v[160:163]
  v_mfma_f32_16x16x32_bf16 v[164:167], v[124:127], v[100:103], v[164:167]
  v_mfma_f32_16x16x32_bf16 v[244:247], v[124:127], v[216:219], v[244:247]
  ds_read_b64_tr_b16 v[148:149], v221 offset:36864
  ds_read_b64_tr_b16 v[150:151], v221 offset:37376
  v_mfma_f32_16x16x32_bf16 v[160:163], v[128:131], v[80:83], v[160:163]
  v_mfma_f32_16x16x32_bf16 v[164:167], v[128:131], v[104:107], v[164:167]
  v_mfma_f32_16x16x32_bf16 v[244:247], v[128:131], v[216:219], v[244:247]
  ds_read_b64_tr_b16 v[152:153], v221 offset:40960
  ds_read_b64_tr_b16 v[154:155], v221 offset:41472
  v_mfma_f32_16x16x32_bf16 v[160:163], v[132:135], v[84:87], v[160:163]
  v_mfma_f32_16x16x32_bf16 v[164:167], v[132:135], v[108:111], v[164:167]
  v_mfma_f32_16x16x32_bf16 v[244:247], v[132:135], v[216:219], v[244:247]
  ds_read_b64_tr_b16 v[156:157], v221 offset:45056
  ds_read_b64_tr_b16 v[158:159], v221 offset:45568
  v_pk_mul_f32 v[160:161], v[160:161], v[12:13] op_sel:[0,0] op_sel_hi:[1,0]
  v_pk_mul_f32 v[162:163], v[162:163], v[12:13] op_sel:[0,0] op_sel_hi:[1,0]
  v_pk_mul_f32 v[164:165], v[164:165], v[60:61] op_sel:[0,0] op_sel_hi:[1,0]
  v_pk_mul_f32 v[166:167], v[166:167], v[60:61] op_sel:[0,0] op_sel_hi:[1,0]
  s_nop 1
  v_pk_fma_f32 v[160:161], v[244:245], v[12:13], v[160:161] op_sel:[0,1,0] op_sel_hi:[1,1,1]
  v_pk_fma_f32 v[162:163], v[246:247], v[12:13], v[162:163] op_sel:[0,1,0] op_sel_hi:[1,1,1]
  v_pk_fma_f32 v[164:165], v[244:245], v[60:61], v[164:165] op_sel:[0,1,0] op_sel_hi:[1,1,1]
  v_pk_fma_f32 v[166:167], v[246:247], v[60:61], v[166:167] op_sel:[0,1,0] op_sel_hi:[1,1,1]
  v_cvt_pk_bf16_f32 v176, v160, v161
  v_cvt_pk_bf16_f32 v177, v162, v163
  v_cvt_pk_bf16_f32 v178, v164, v165
  v_cvt_pk_bf16_f32 v179, v166, v167
  s_waitcnt lgkmcnt(0)
  s_barrier
  v_mfma_f32_16x16x32_bf16 v[168:171], v[136:139], v[64:67], 0
  v_mfma_f32_16x16x32_bf16 v[172:175], v[136:139], v[88:91], 0
  v_mfma_f32_16x16x32_bf16 v[248:251], v[136:139], v[216:219], 0
  ds_read_b64_tr_b16 v[112:113], v222 offset:0
  ds_read_b64_tr_b16 v[114:115], v222 offset:512
  v_mfma_f32_16x16x32_bf16 v[168:171], v[140:143], v[68:71], v[168:171]
  v_mfma_f32_16x16x32_bf16 v[172:175], v[140:143], v[92:95], v[172:175]
  v_mfma_f32_16x16x32_bf16 v[248:251], v[140:143], v[216:219], v[248:251]
  ds_read_b64_tr_b16 v[116:117], v222 offset:4096
  ds_read_b64_tr_b16 v[118:119], v222 offset:4608
  v_mfma_f32_16x16x32_bf16 v[168:171], v[144:147], v[72:75], v[168:171]
  v_mfma_f32_16x16x32_bf16 v[172:175], v[144:147], v[96:99], v[172:175]
  v_mfma_f32_16x16x32_bf16 v[248:251], v[144:147], v[216:219], v[248:251]
  ds_read_b64_tr_b16 v[120:121], v222 offset:8192
  ds_read_b64_tr_b16 v[122:123], v222 offset:8704
  v_mfma_f32_16x16x32_bf16 v[168:171], v[148:151], v[76:79], v[168:171]
  v_mfma_f32_16x16x32_bf16 v[172:175], v[148:151], v[100:103], v[172:175]
  v_mfma_f32_16x16x32_bf16 v[248:251], v[148:151], v[216:219], v[248:251]
  ds_read_b64_tr_b16 v[124:125], v222 offset:12288
  ds_read_b64_tr_b16 v[126:127], v222 offset:12800
  v_mfma_f32_16x16x32_bf16 v[168:171], v[152:155], v[80:83], v[168:171]
  v_mfma_f32_16x16x32_bf16 v[172:175], v[152:155], v[104:107], v[172:175]
  v_mfma_f32_16x16x32_bf16 v[248:251], v[152:155], v[216:219], v[248:251]
  ds_read_b64_tr_b16 v[128:129], v222 offset:16384
  ds_read_b64_tr_b16 v[130:131], v222 offset:16896
  v_mfma_f32_16x16x32_bf16 v[168:171], v[156:159], v[84:87], v[168:171]
  v_mfma_f32_16x16x32_bf16 v[172:175], v[156:159], v[108:111], v[172:175]
  v_mfma_f32_16x16x32_bf16 v[248:251], v[156:159], v[216:219], v[248:251]
  ds_read_b64_tr_b16 v[132:133], v222 offset:20480
  ds_read_b64_tr_b16 v[134:135], v222 offset:20992
.Lk1_pad5:
  s_cbranch_execz .Lk1_pad9
  v_pk_mul_f32 v[168:169], v[168:169], v[12:13] op_sel:[0,0] op_sel_hi:[1,0]
  v_pk_mul_f32 v[170:171], v[170:171], v[12:13] op_sel:[0,0] op_sel_hi:[1,0]
  v_pk_mul_f32 v[172:173], v[172:173], v[60:61] op_sel:[0,0] op_sel_hi:[1,0]
  v_pk_mul_f32 v[174:175], v[174:175], v[60:61] op_sel:[0,0] op_sel_hi:[1,0]
  s_nop 1
  v_pk_fma_f32 v[168:169], v[248:249], v[12:13], v[168:169] op_sel:[0,1,0] op_sel_hi:[1,1,1]
  v_pk_fma_f32 v[170:171], v[250:251], v[12:13], v[170:171] op_sel:[0,1,0] op_sel_hi:[1,1,1]
  v_pk_fma_f32 v[172:173], v[248:249], v[60:61], v[172:173] op_sel:[0,1,0] op_sel_hi:[1,1,1]
  v_pk_fma_f32 v[174:175], v[250:251], v[60:61], v[174:175] op_sel:[0,1,0] op_sel_hi:[1,1,1]
  v_cvt_pk_bf16_f32 v180, v168, v169
  v_cvt_pk_bf16_f32 v181, v170, v171
  v_cvt_pk_bf16_f32 v182, v172, v173
  v_cvt_pk_bf16_f32 v183, v174, v175
  v_mfma_f32_16x16x16_bf16 v[184:187], v[180:181], v[176:177], v[184:187]
  s_nop 0
  v_mfma_f32_16x16x16_bf16 v[188:191], v[182:183], v[178:179], v[188:191]
  s_waitcnt lgkmcnt(0)
  s_barrier
  v_mfma_f32_16x16x32_bf16 v[160:163], v[112:115], v[64:67], 0
  v_mfma_f32_16x16x32_bf16 v[164:167], v[112:115], v[88:91], 0
  v_mfma_f32_16x16x32_bf16 v[244:247], v[112:115], v[216:219], 0
  ds_read_b64_tr_b16 v[136:137], v222 offset:24576
  ds_read_b64_tr_b16 v[138:139], v222 offset:25088
  v_mfma_f32_16x16x32_bf16 v[160:163], v[116:119], v[68:71], v[160:163]
  v_mfma_f32_16x16x32_bf16 v[164:167], v[116:119], v[92:95], v[164:167]
  v_mfma_f32_16x16x32_bf16 v[244:247], v[116:119], v[216:219], v[244:247]
  ds_read_b64_tr_b16 v[140:141], v222 offset:28672
  ds_read_b64_tr_b16 v[142:143], v222 offset:29184
  v_mfma_f32_16x16x32_bf16 v[160:163], v[120:123], v[72:75], v[160:163]
  v_mfma_f32_16x16x32_bf16 v[164:167], v[120:123], v[96:99], v[164:167]
  v_mfma_f32_16x16x32_bf16 v[244:247], v[120:123], v[216:219], v[244:247]
  ds_read_b64_tr_b16 v[144:145], v222 offset:32768
  ds_read_b64_tr_b16 v[146:147], v222 offset:33280
  v_mfma_f32_16x16x32_bf16 v[160:163], v[124:127], v[76:79], v[160:163]
  v_mfma_f32_16x16x32_bf16 v[164:167], v[124:127], v[100:103], v[164:167]
  v_mfma_f32_16x16x32_bf16 v[244:247], v[124:127], v[216:219], v[244:247]
  ds_read_b64_tr_b16 v[148:149], v222 offset:36864
  ds_read_b64_tr_b16 v[150:151], v222 offset:37376
  v_mfma_f32_16x16x32_bf16 v[160:163], v[128:131], v[80:83], v[160:163]
  v_mfma_f32_16x16x32_bf16 v[164:167], v[128:131], v[104:107], v[164:167]
  v_mfma_f32_16x16x32_bf16 v[244:247], v[128:131], v[216:219], v[244:247]
  ds_read_b64_tr_b16 v[152:153], v222 offset:40960
  ds_read_b64_tr_b16 v[154:155], v222 offset:41472
  v_mfma_f32_16x16x32_bf16 v[160:163], v[132:135], v[84:87], v[160:163]
  v_mfma_f32_16x16x32_bf16 v[164:167], v[132:135], v[108:111], v[164:167]
  v_mfma_f32_16x16x32_bf16 v[244:247], v[132:135], v[216:219], v[244:247]
  ds_read_b64_tr_b16 v[156:157], v222 offset:45056
  ds_read_b64_tr_b16 v[158:159], v222 offset:45568
  v_pk_mul_f32 v[160:161], v[160:161], v[12:13] op_sel:[0,0] op_sel_hi:[1,0]
  v_pk_mul_f32 v[162:163], v[162:163], v[12:13] op_sel:[0,0] op_sel_hi:[1,0]
  v_pk_mul_f32 v[164:165], v[164:165], v[60:61] op_sel:[0,0] op_sel_hi:[1,0]
  v_pk_mul_f32 v[166:167], v[166:167], v[60:61] op_sel:[0,0] op_sel_hi:[1,0]
  s_nop 1
  v_pk_fma_f32 v[160:161], v[244:245], v[12:13], v[160:161] op_sel:[0,1,0] op_sel_hi:[1,1,1]
  v_pk_fma_f32 v[162:163], v[246:247], v[12:13], v[162:163] op_sel:[0,1,0] op_sel_hi:[1,1,1]
  v_pk_fma_f32 v[164:165], v[244:245], v[60:61], v[164:165] op_sel:[0,1,0] op_sel_hi:[1,1,1]
  v_pk_fma_f32 v[166:167], v[246:247], v[60:61], v[166:167] op_sel:[0,1,0] op_sel_hi:[1,1,1]
  v_cvt_pk_bf16_f32 v176, v160, v161
  v_cvt_pk_bf16_f32 v177, v162, v163
  v_cvt_pk_bf16_f32 v178, v164, v165
  v_cvt_pk_bf16_f32 v179, v166, v167
  s_waitcnt lgkmcnt(0)
  s_barrier
  v_mfma_f32_16x16x32_bf16 v[168:171], v[136:139], v[64:67], 0
  v_mfma_f32_16x16x32_bf16 v[172:175], v[136:139], v[88:91], 0
  v_mfma_f32_16x16x32_bf16 v[248:251], v[136:139], v[216:219], 0
  ds_read_b64_tr_b16 v[112:113], v220 offset:0
  ds_read_b64_tr_b16 v[114:115], v220 offset:512
  v_mfma_f32_16x16x32_bf16 v[168:171], v[140:143], v[68:71], v[168:171]
  v_mfma_f32_16x16x32_bf16 v[172:175], v[140:143], v[92:95], v[172:175]
  v_mfma_f32_16x16x32_bf16 v[248:251], v[140:143], v[216:219], v[248:251]
  ds_read_b64_tr_b16 v[116:117], v220 offset:4096
  ds_read_b64_tr_b16 v[118:119], v220 offset:4608
  v_mfma_f32_16x16x32_bf16 v[168:171], v[144:147], v[72:75], v[168:171]
  v_mfma_f32_16x16x32_bf16 v[172:175], v[144:147], v[96:99], v[172:175]
  v_mfma_f32_16x16x32_bf16 v[248:251], v[144:147], v[216:219], v[248:251]
  ds_read_b64_tr_b16 v[120:121], v220 offset:8192
  ds_read_b64_tr_b16 v[122:123], v220 offset:8704
  v_mfma_f32_16x16x32_bf16 v[168:171], v[148:151], v[76:79], v[168:171]
  v_mfma_f32_16x16x32_bf16 v[172:175], v[148:151], v[100:103], v[172:175]
  v_mfma_f32_16x16x32_bf16 v[248:251], v[148:151], v[216:219], v[248:251]
  ds_read_b64_tr_b16 v[124:125], v220 offset:12288
  ds_read_b64_tr_b16 v[126:127], v220 offset:12800
  v_mfma_f32_16x16x32_bf16 v[168:171], v[152:155], v[80:83], v[168:171]
  v_mfma_f32_16x16x32_bf16 v[172:175], v[152:155], v[104:107], v[172:175]
  v_mfma_f32_16x16x32_bf16 v[248:251], v[152:155], v[216:219], v[248:251]
  ds_read_b64_tr_b16 v[128:129], v220 offset:16384
  ds_read_b64_tr_b16 v[130:131], v220 offset:16896
  v_mfma_f32_16x16x32_bf16 v[168:171], v[156:159], v[84:87], v[168:171]
  v_mfma_f32_16x16x32_bf16 v[172:175], v[156:159], v[108:111], v[172:175]
  v_mfma_f32_16x16x32_bf16 v[248:251], v[156:159], v[216:219], v[248:251]
  ds_read_b64_tr_b16 v[132:133], v220 offset:20480
  ds_read_b64_tr_b16 v[134:135], v220 offset:20992
  s_mov_b64 vcc, s[10:11]
  v_pk_mul_f32 v[168:169], v[168:169], v[12:13] op_sel:[0,0] op_sel_hi:[1,0]
  v_pk_mul_f32 v[170:171], v[170:171], v[12:13] op_sel:[0,0] op_sel_hi:[1,0]
  v_pk_mul_f32 v[172:173], v[172:173], v[60:61] op_sel:[0,0] op_sel_hi:[1,0]
  v_pk_mul_f32 v[174:175], v[174:175], v[60:61] op_sel:[0,0] op_sel_hi:[1,0]
  s_nop 0
  v_pk_fma_f32 v[168:169], v[248:249], v[12:13], v[168:169] op_sel:[0,1,0] op_sel_hi:[1,1,1]
  v_pk_fma_f32 v[170:171], v[250:251], v[12:13], v[170:171] op_sel:[0,1,0] op_sel_hi:[1,1,1]
  v_pk_fma_f32 v[172:173], v[248:249], v[60:61], v[172:173] op_sel:[0,1,0] op_sel_hi:[1,1,1]
  v_pk_fma_f32 v[174:175], v[250:251], v[60:61], v[174:175] op_sel:[0,1,0] op_sel_hi:[1,1,1]
  v_cvt_pk_bf16_f32 v180, v168, v169
  v_cvt_pk_bf16_f32 v181, v170, v171
  v_cvt_pk_bf16_f32 v182, v172, v173
  v_cvt_pk_bf16_f32 v183, v174, v175
  v_mfma_f32_16x16x16_bf16 v[184:187], v[180:181], v[176:177], v[184:187]
  s_nop 0
  v_mfma_f32_16x16x16_bf16 v[188:191], v[182:183], v[178:179], v[188:191]
  s_nop 7
  v_cndmask_b32_dpp v44, v188, v184, vcc row_ror:8 row_mask:0xf bank_mask:0xf
  v_cndmask_b32_dpp v45, v189, v185, vcc row_ror:8 row_mask:0xf bank_mask:0xf
  v_cndmask_b32_dpp v46, v190, v186, vcc row_ror:8 row_mask:0xf bank_mask:0xf
  v_cndmask_b32_dpp v47, v191, v187, vcc row_ror:8 row_mask:0xf bank_mask:0xf
  ds_write_b128 v227, v[44:47]
  s_waitcnt lgkmcnt(0)
  s_barrier
  ds_read_b128 v[44:47], v228 offset:0
  ds_read_b128 v[48:51], v228 offset:1024
  ds_read_b128 v[52:55], v228 offset:2048
  ds_read_b128 v[56:59], v228 offset:3072
  v_mfma_f32_16x16x32_bf16 v[160:163], v[64:67], v[112:115], 0
  v_mfma_f32_16x16x32_bf16 v[164:167], v[88:91], v[112:115], 0
  ds_read_b64_tr_b16 v[136:137], v220 offset:24576
  ds_read_b64_tr_b16 v[138:139], v220 offset:25088
  ds_read_b64_tr_b16 v[140:141], v220 offset:28672
  v_mfma_f32_16x16x32_bf16 v[244:247], v[216:219], v[112:115], 0
  v_mfma_f32_16x16x32_bf16 v[160:163], v[68:71], v[116:119], v[160:163]
  ds_read_b64_tr_b16 v[142:143], v220 offset:29184
  ds_read_b64_tr_b16 v[144:145], v220 offset:32768
  ds_read_b64_tr_b16 v[146:147], v220 offset:33280
  v_mfma_f32_16x16x32_bf16 v[164:167], v[92:95], v[116:119], v[164:167]
  v_mfma_f32_16x16x32_bf16 v[244:247], v[216:219], v[116:119], v[244:247]
.Lk1_pad6:
  s_cbranch_execz .Lk1_pad10
  ds_read_b64_tr_b16 v[148:149], v220 offset:36864
  ds_read_b64_tr_b16 v[150:151], v220 offset:37376
  ds_read_b64_tr_b16 v[152:153], v220 offset:40960
  v_mfma_f32_16x16x32_bf16 v[160:163], v[72:75], v[120:123], v[160:163]
  v_mfma_f32_16x16x32_bf16 v[164:167], v[96:99], v[120:123], v[164:167]
  ds_read_b64_tr_b16 v[154:155], v220 offset:41472
  ds_read_b64_tr_b16 v[156:157], v220 offset:45056
  ds_read_b64_tr_b16 v[158:159], v220 offset:45568
  v_mfma_f32_16x16x32_bf16 v[244:247], v[216:219], v[120:123], v[244:247]
  s_waitcnt lgkmcnt(14)
  v_pk_add_f32 v[44:45], v[44:45], v[48:49]
  s_waitcnt lgkmcnt(12)
  s_nop 0
  v_pk_add_f32 v[52:53], v[52:53], v[56:57]
  v_pk_add_f32 v[46:47], v[46:47], v[50:51]
  v_pk_add_f32 v[54:55], v[54:55], v[58:59]
  v_mfma_f32_16x16x32_bf16 v[160:163], v[76:79], v[124:127], v[160:163]
  v_pk_add_f32 v[44:45], v[44:45], v[52:53]
  v_pk_add_f32 v[46:47], v[46:47], v[54:55]
  v_max3_f32 v236, v44, v45, v46
  v_max_f32_e64 v236, v236, v47
  v_mfma_f32_16x16x32_bf16 v[164:167], v[100:103], v[124:127], v[164:167]
  v_mov_b32 v237, v236
  s_nop 1
  v_permlane16_swap_b32 v236, v237
  v_max_f32 v236, v236, v237
  v_mul_f32 v236, 0xbdd53b95, v236
  v_mfma_f32_16x16x32_bf16 v[244:247], v[216:219], v[124:127], v[244:247]
  v_mov_b32 v238, 0x3dd53b95
  v_fma_f32 v44, v44, v238, v236
  v_fma_f32 v45, v45, v238, v236
  v_fma_f32 v46, v46, v238, v236
  v_mfma_f32_16x16x32_bf16 v[160:163], v[80:83], v[128:131], v[160:163]
  v_fma_f32 v47, v47, v238, v236
  v_exp_f32 v44, v44
  v_exp_f32 v45, v45
  v_exp_f32_e64 v46, v46
  v_mfma_f32_16x16x32_bf16 v[164:167], v[104:107], v[128:131], v[164:167]
  v_exp_f32 v47, v47
  s_nop 0
  v_pk_add_f32 v[236:237], v[44:45], v[46:47]
  v_add_f32 v236, v236, v237
  v_mov_b32 v237, v236
  v_mfma_f32_16x16x32_bf16 v[244:247], v[216:219], v[128:131], v[244:247]
  s_nop 0
  v_permlane16_swap_b32 v236, v237
  v_add_f32 v236, v236, v237
  v_rcp_f32 v236, v236
  s_nop 0
  v_pk_mul_f32 v[44:45], v[44:45], v[236:237] op_sel_hi:[1,0]
  v_mfma_f32_16x16x32_bf16 v[160:163], v[84:87], v[132:135], v[160:163]
  v_pk_mul_f32 v[46:47], v[46:47], v[236:237] op_sel_hi:[1,0]
  v_cvt_pk_bf16_f32 v238, v44, v45
  v_cvt_pk_bf16_f32 v239, v46, v47
  v_and_b32 v204, v238, v231
  v_mfma_f32_16x16x32_bf16 v[164:167], v[108:111], v[132:135], v[164:167]
  v_and_b32_e64 v205, v239, v231
  v_and_b32_dpp v206, v238, v231 row_ror:8 row_mask:0xf bank_mask:0xf
  v_and_b32_dpp v207, v239, v231 row_ror:8 row_mask:0xf bank_mask:0xf
  v_mfma_f32_16x16x32_bf16 v[244:247], v[216:219], v[132:135], v[244:247]
  v_pk_mul_f32 v[160:161], v[160:161], v[4:5]
  v_pk_mul_f32 v[162:163], v[162:163], v[6:7]
  s_nop 1
  v_pk_mul_f32 v[164:165], v[164:165], v[8:9]
  v_pk_mul_f32 v[166:167], v[166:167], v[10:11]
  s_nop 1
  v_pk_fma_f32 v[160:161], v[244:245], v[252:253], v[160:161]
  v_pk_fma_f32 v[162:163], v[246:247], v[254:255], v[162:163]
  v_pk_fma_f32 v[164:165], v[244:245], v[240:241], v[164:165]
  v_pk_fma_f32 v[166:167], v[246:247], v[242:243], v[166:167]
  v_cvt_pk_bf16_f32 v192, v160, v161
  v_cvt_pk_bf16_f32 v193, v162, v163
  v_cvt_pk_bf16_f32 v194, v164, v165
  v_cvt_pk_bf16_f32 v195, v166, v167
  v_mfma_f32_16x16x16_bf16 v[208:211], v[192:193], v[204:205], 0
  s_nop 0
  v_mfma_f32_16x16x16_bf16 v[212:215], v[194:195], v[206:207], 0
  s_nop 3
  v_cvt_pk_bf16_f32 v208, v208, v209
  v_cvt_pk_bf16_f32 v209, v210, v211
  s_nop 1
  v_cvt_pk_bf16_f32 v212, v212, v213
  v_cvt_pk_bf16_f32 v213, v214, v215
  ds_write_b64 v225, v[208:209] offset:0
  ds_write_b64 v225, v[212:213] offset:6144
  s_waitcnt lgkmcnt(0)
  s_barrier
  v_mfma_f32_16x16x32_bf16 v[168:171], v[64:67], v[136:139], 0
  v_mfma_f32_16x16x32_bf16 v[172:175], v[88:91], v[136:139], 0
  v_mfma_f32_16x16x32_bf16 v[248:251], v[216:219], v[136:139], 0
  ds_read_b64_tr_b16 v[112:113], v221 offset:0
  ds_read_b64_tr_b16 v[114:115], v221 offset:512
  v_mfma_f32_16x16x32_bf16 v[168:171], v[68:71], v[140:143], v[168:171]
  v_mfma_f32_16x16x32_bf16 v[172:175], v[92:95], v[140:143], v[172:175]
  v_mfma_f32_16x16x32_bf16 v[248:251], v[216:219], v[140:143], v[248:251]
  ds_read_b64_tr_b16 v[116:117], v221 offset:4096
  ds_read_b64_tr_b16 v[118:119], v221 offset:4608
  v_mfma_f32_16x16x32_bf16 v[168:171], v[72:75], v[144:147], v[168:171]
  v_mfma_f32_16x16x32_bf16 v[172:175], v[96:99], v[144:147], v[172:175]
  v_mfma_f32_16x16x32_bf16 v[248:251], v[216:219], v[144:147], v[248:251]
  ds_read_b64_tr_b16 v[120:121], v221 offset:8192
  ds_read_b64_tr_b16 v[122:123], v221 offset:8704
  v_mfma_f32_16x16x32_bf16 v[168:171], v[76:79], v[148:151], v[168:171]
  v_mfma_f32_16x16x32_bf16 v[172:175], v[100:103], v[148:151], v[172:175]
  v_mfma_f32_16x16x32_bf16 v[248:251], v[216:219], v[148:151], v[248:251]
  ds_read_b64_tr_b16 v[124:125], v221 offset:12288
  ds_read_b64_tr_b16 v[126:127], v221 offset:12800
  v_mfma_f32_16x16x32_bf16 v[168:171], v[80:83], v[152:155], v[168:171]
  v_mfma_f32_16x16x32_bf16 v[172:175], v[104:107], v[152:155], v[172:175]
  v_mfma_f32_16x16x32_bf16 v[248:251], v[216:219], v[152:155], v[248:251]
  ds_read_b64_tr_b16 v[128:129], v221 offset:16384
  ds_read_b64_tr_b16 v[130:131], v221 offset:16896
  v_mfma_f32_16x16x32_bf16 v[168:171], v[84:87], v[156:159], v[168:171]
  v_mfma_f32_16x16x32_bf16 v[172:175], v[108:111], v[156:159], v[172:175]
  v_mfma_f32_16x16x32_bf16 v[248:251], v[216:219], v[156:159], v[248:251]
  ds_read_b64_tr_b16 v[132:133], v221 offset:20480
  ds_read_b64_tr_b16 v[134:135], v221 offset:20992
  v_pk_mul_f32 v[168:169], v[168:169], v[4:5]
  v_pk_mul_f32 v[170:171], v[170:171], v[6:7]
  v_pk_mul_f32 v[172:173], v[172:173], v[8:9]
  v_pk_mul_f32 v[174:175], v[174:175], v[10:11]
  s_nop 1
  v_pk_fma_f32 v[168:169], v[248:249], v[252:253], v[168:169]
  v_pk_fma_f32 v[170:171], v[250:251], v[254:255], v[170:171]
  v_pk_fma_f32 v[172:173], v[248:249], v[240:241], v[172:173]
  v_pk_fma_f32 v[174:175], v[250:251], v[242:243], v[174:175]
  v_cvt_pk_bf16_f32 v196, v168, v169
  v_cvt_pk_bf16_f32 v197, v170, v171
  v_cvt_pk_bf16_f32 v198, v172, v173
  v_cvt_pk_bf16_f32 v199, v174, v175
  v_mfma_f32_16x16x16_bf16 v[208:211], v[196:197], v[204:205], 0
  s_nop 0
  v_mfma_f32_16x16x16_bf16 v[212:215], v[198:199], v[206:207], 0
  s_nop 3
  v_cvt_pk_bf16_f32 v208, v208, v209
  v_cvt_pk_bf16_f32 v209, v210, v211
  s_nop 1
  v_cvt_pk_bf16_f32 v212, v212, v213
  v_cvt_pk_bf16_f32 v213, v214, v215
  ds_write_b64 v225, v[208:209] offset:128
  ds_write_b64 v225, v[212:213] offset:6272
  s_waitcnt lgkmcnt(0)
  s_barrier
  v_mfma_f32_16x16x32_bf16 v[160:163], v[64:67], v[112:115], 0
.Lk1_pad7:
  s_cbranch_execz k1_retc
  v_mfma_f32_16x16x32_bf16 v[164:167], v[88:91], v[112:115], 0
  v_mfma_f32_16x16x32_bf16 v[244:247], v[216:219], v[112:115], 0
  ds_read_b64_tr_b16 v[136:137], v221 offset:24576
  ds_read_b64_tr_b16 v[138:139], v221 offset:25088
  v_mfma_f32_16x16x32_bf16 v[160:163], v[68:71], v[116:119], v[160:163]
  v_mfma_f32_16x16x32_bf16 v[164:167], v[92:95], v[116:119], v[164:167]
  v_mfma_f32_16x16x32_bf16 v[244:247], v[216:219], v[116:119], v[244:247]
  ds_read_b64_tr_b16 v[140:141], v221 offset:28672
  ds_read_b64_tr_b16 v[142:143], v221 offset:29184
  v_mfma_f32_16x16x32_bf16 v[160:163], v[72:75], v[120:123], v[160:163]
  v_mfma_f32_16x16x32_bf16 v[164:167], v[96:99], v[120:123], v[164:167]
  v_mfma_f32_16x16x32_bf16 v[244:247], v[216:219], v[120:123], v[244:247]
  ds_read_b64_tr_b16 v[144:145], v221 offset:32768
  ds_read_b64_tr_b16 v[146:147], v221 offset:33280
  v_mfma_f32_16x16x32_bf16 v[160:163], v[76:79], v[124:127], v[160:163]
  v_mfma_f32_16x16x32_bf16 v[164:167], v[100:103], v[124:127], v[164:167]
  v_mfma_f32_16x16x32_bf16 v[244:247], v[216:219], v[124:127], v[244:247]
  ds_read_b64_tr_b16 v[148:149], v221 offset:36864
  ds_read_b64_tr_b16 v[150:151], v221 offset:37376
  v_mfma_f32_16x16x32_bf16 v[160:163], v[80:83], v[128:131], v[160:163]
  v_mfma_f32_16x16x32_bf16 v[164:167], v[104:107], v[128:131], v[164:167]
  v_mfma_f32_16x16x32_bf16 v[244:247], v[216:219], v[128:131], v[244:247]
  ds_read_b64_tr_b16 v[152:153], v221 offset:40960
  ds_read_b64_tr_b16 v[154:155], v221 offset:41472
  v_mfma_f32_16x16x32_bf16 v[160:163], v[84:87], v[132:135], v[160:163]
  v_mfma_f32_16x16x32_bf16 v[164:167], v[108:111], v[132:135], v[164:167]
  v_mfma_f32_16x16x32_bf16 v[244:247], v[216:219], v[132:135], v[244:247]
  ds_read_b64_tr_b16 v[156:157], v221 offset:45056
  ds_read_b64_tr_b16 v[158:159], v221 offset:45568
  ds_read_b128 v[64:67], v223 offset:0
  ds_read_b128 v[88:91], v223 offset:6144
  ds_read_b128 v[68:71], v224 offset:0
  ds_read_b128 v[92:95], v224 offset:6144
  ds_read_b128 v[72:75], v223 offset:128
  ds_read_b128 v[96:99], v223 offset:6272
  ds_read_b128 v[76:79], v224 offset:128
  ds_read_b128 v[100:103], v224 offset:6272
  v_pk_mul_f32 v[160:161], v[160:161], v[4:5]
  v_pk_mul_f32 v[162:163], v[162:163], v[6:7]
  v_pk_mul_f32 v[164:165], v[164:165], v[8:9]
  v_pk_mul_f32 v[166:167], v[166:167], v[10:11]
  v_pk_fma_f32 v[160:161], v[244:245], v[252:253], v[160:161]
  v_pk_fma_f32 v[162:163], v[246:247], v[254:255], v[162:163]
  v_pk_fma_f32 v[164:165], v[244:245], v[240:241], v[164:165]
  v_pk_fma_f32 v[166:167], v[246:247], v[242:243], v[166:167]
  v_cvt_pk_bf16_f32 v200, v160, v161
  v_cvt_pk_bf16_f32 v201, v162, v163
  v_cvt_pk_bf16_f32 v202, v164, v165
  v_cvt_pk_bf16_f32 v203, v166, v167
  v_mfma_f32_16x16x16_bf16 v[208:211], v[200:201], v[204:205], 0
  s_nop 0
  v_mfma_f32_16x16x16_bf16 v[212:215], v[202:203], v[206:207], 0
  s_nop 3
  v_cvt_pk_bf16_f32 v208, v208, v209
  v_cvt_pk_bf16_f32 v209, v210, v211
  s_nop 1
  v_cvt_pk_bf16_f32 v212, v212, v213
  v_cvt_pk_bf16_f32 v213, v214, v215
  ds_write_b64 v225, v[208:209] offset:256
  ds_write_b64 v225, v[212:213] offset:6400
  s_waitcnt lgkmcnt(0)
  s_barrier
  ds_read_b128 v[80:83], v223 offset:256
  ds_read_b128 v[104:107], v223 offset:6400
  ds_read_b128 v[84:87], v224 offset:256
  ds_read_b128 v[108:111], v224 offset:6400
  v_mfma_f32_16x16x32_bf16 v[16:19], v[136:139], v[64:67], v[16:19]
  ds_read_b64_tr_b16 v[112:113], v222 offset:0
  v_mfma_f32_16x16x32_bf16 v[20:23], v[136:139], v[88:91], v[20:23]
  ds_read_b64_tr_b16 v[114:115], v222 offset:512
  v_mfma_f32_16x16x32_bf16 v[16:19], v[140:143], v[68:71], v[16:19]
  ds_read_b64_tr_b16 v[116:117], v222 offset:4096
  v_mfma_f32_16x16x32_bf16 v[20:23], v[140:143], v[92:95], v[20:23]
  ds_read_b64_tr_b16 v[118:119], v222 offset:4608
  v_mfma_f32_16x16x32_bf16 v[16:19], v[144:147], v[72:75], v[16:19]
  ds_read_b64_tr_b16 v[120:121], v222 offset:8192
  v_mfma_f32_16x16x32_bf16 v[20:23], v[144:147], v[96:99], v[20:23]
  ds_read_b64_tr_b16 v[122:123], v222 offset:8704
  v_mfma_f32_16x16x32_bf16 v[16:19], v[148:151], v[76:79], v[16:19]
  ds_read_b64_tr_b16 v[124:125], v222 offset:12288
  v_mfma_f32_16x16x32_bf16 v[20:23], v[148:151], v[100:103], v[20:23]
  ds_read_b64_tr_b16 v[126:127], v222 offset:12800
  s_waitcnt lgkmcnt(11)
  v_mfma_f32_16x16x32_bf16 v[16:19], v[152:155], v[80:83], v[16:19]
  ds_read_b64_tr_b16 v[128:129], v222 offset:16384
  s_waitcnt lgkmcnt(11)
  v_mfma_f32_16x16x32_bf16 v[20:23], v[152:155], v[104:107], v[20:23]
  ds_read_b64_tr_b16 v[130:131], v222 offset:16896
  s_waitcnt lgkmcnt(11)
  v_mfma_f32_16x16x32_bf16 v[16:19], v[156:159], v[84:87], v[16:19]
  ds_read_b64_tr_b16 v[132:133], v222 offset:20480
  s_waitcnt lgkmcnt(11)
  v_mfma_f32_16x16x32_bf16 v[20:23], v[156:159], v[108:111], v[20:23]
  ds_read_b64_tr_b16 v[134:135], v222 offset:20992
  s_waitcnt lgkmcnt(10)
  v_mfma_f32_16x16x32_bf16 v[24:27], v[112:115], v[64:67], v[24:27]
  v_mfma_f32_16x16x32_bf16 v[28:31], v[112:115], v[88:91], v[28:31]
  s_waitcnt lgkmcnt(8)
  v_mfma_f32_16x16x32_bf16 v[24:27], v[116:119], v[68:71], v[24:27]
  v_mfma_f32_16x16x32_bf16 v[28:31], v[116:119], v[92:95], v[28:31]
  s_waitcnt lgkmcnt(6)
  v_mfma_f32_16x16x32_bf16 v[24:27], v[120:123], v[72:75], v[24:27]
  v_pk_add_f32 v[4:5], v[16:17], v[18:19]
  v_mfma_f32_16x16x32_bf16 v[28:31], v[120:123], v[96:99], v[28:31]
  v_pk_add_f32 v[8:9], v[20:21], v[22:23]
  s_waitcnt lgkmcnt(4)
  v_mfma_f32_16x16x32_bf16 v[24:27], v[124:127], v[76:79], v[24:27]
  v_pk_mul_f32 v[6:7], v[16:17], v[16:17]
  v_mfma_f32_16x16x32_bf16 v[28:31], v[124:127], v[100:103], v[28:31]
  v_pk_mul_f32 v[10:11], v[20:21], v[20:21]
  s_waitcnt lgkmcnt(2)
  v_mfma_f32_16x16x32_bf16 v[24:27], v[128:131], v[80:83], v[24:27]
  v_pk_fma_f32 v[6:7], v[18:19], v[18:19], v[6:7]
  v_mfma_f32_16x16x32_bf16 v[28:31], v[128:131], v[104:107], v[28:31]
  v_pk_fma_f32 v[10:11], v[22:23], v[22:23], v[10:11]
  s_waitcnt lgkmcnt(0)
  v_mfma_f32_16x16x32_bf16 v[24:27], v[132:135], v[84:87], v[24:27]
  v_mfma_f32_16x16x32_bf16 v[28:31], v[132:135], v[108:111], v[28:31]
  s_barrier
  ds_read_b64_tr_b16 v[136:137], v222 offset:24576
  ds_read_b64_tr_b16 v[138:139], v222 offset:25088
  ds_read_b64_tr_b16 v[140:141], v222 offset:28672
  ds_read_b64_tr_b16 v[142:143], v222 offset:29184
  ds_read_b64_tr_b16 v[144:145], v222 offset:32768
  ds_read_b64_tr_b16 v[146:147], v222 offset:33280
  ds_read_b64_tr_b16 v[148:149], v222 offset:36864
  ds_read_b64_tr_b16 v[150:151], v222 offset:37376
  ds_read_b64_tr_b16 v[152:153], v222 offset:40960
  ds_read_b64_tr_b16 v[154:155], v222 offset:41472
  ds_read_b64_tr_b16 v[156:157], v222 offset:45056
  ds_read_b64_tr_b16 v[158:159], v222 offset:45568
  v_pk_add_f32 v[4:5], v[4:5], v[24:25]
  v_pk_add_f32 v[8:9], v[8:9], v[28:29]
  v_pk_fma_f32 v[6:7], v[24:25], v[24:25], v[6:7]
  v_pk_fma_f32 v[10:11], v[28:29], v[28:29], v[10:11]
.Lk1_pad8:
  s_cbranch_execz k1_retc
  v_pk_add_f32 v[4:5], v[4:5], v[26:27]
  v_pk_add_f32 v[8:9], v[8:9], v[30:31]
  v_pk_fma_f32 v[6:7], v[26:27], v[26:27], v[6:7]
  v_pk_fma_f32 v[10:11], v[30:31], v[30:31], v[10:11]
  s_lshr_b32 s8, s2, 3
  s_mul_i32 s8, s8, 12288
  s_add_u32 s9, s8, 4096
  s_add_u32 s12, s8, 8192
  s_lshl_b32 s13, s4, 3
  s_add_u32 s13, s13, 3145728
  s_waitcnt lgkmcnt(10)
  v_mfma_f32_16x16x32_bf16 v[32:35], v[136:139], v[64:67], v[32:35]
  v_mfma_f32_16x16x32_bf16 v[36:39], v[136:139], v[88:91], v[36:39]
  s_waitcnt lgkmcnt(8)
  v_mfma_f32_16x16x32_bf16 v[32:35], v[140:143], v[68:71], v[32:35]
  v_mfma_f32_16x16x32_bf16 v[36:39], v[140:143], v[92:95], v[36:39]
  s_waitcnt lgkmcnt(6)
  v_mfma_f32_16x16x32_bf16 v[32:35], v[144:147], v[72:75], v[32:35]
  v_mfma_f32_16x16x32_bf16 v[36:39], v[144:147], v[96:99], v[36:39]
  s_waitcnt lgkmcnt(4)
  v_mfma_f32_16x16x32_bf16 v[32:35], v[148:151], v[76:79], v[32:35]
  v_mfma_f32_16x16x32_bf16 v[36:39], v[148:151], v[100:103], v[36:39]
  s_waitcnt lgkmcnt(2)
  v_mfma_f32_16x16x32_bf16 v[32:35], v[152:155], v[80:83], v[32:35]
  v_mfma_f32_16x16x32_bf16 v[36:39], v[152:155], v[104:107], v[36:39]
  s_waitcnt lgkmcnt(0)
  v_mfma_f32_16x16x32_bf16 v[32:35], v[156:159], v[84:87], v[32:35]
  v_mfma_f32_16x16x32_bf16 v[36:39], v[156:159], v[108:111], v[36:39]
  s_nop 3
  v_pk_add_f32 v[4:5], v[4:5], v[32:33]
  s_nop 2
  s_nop 0
  v_pk_add_f32 v[8:9], v[8:9], v[36:37]
  v_pk_fma_f32 v[6:7], v[32:33], v[32:33], v[6:7]
  v_pk_fma_f32 v[10:11], v[36:37], v[36:37], v[10:11]
  v_pk_add_f32 v[4:5], v[4:5], v[34:35]
  v_pk_add_f32 v[8:9], v[8:9], v[38:39]
  v_pk_fma_f32 v[6:7], v[34:35], v[34:35], v[6:7]
  v_pk_fma_f32 v[10:11], v[38:39], v[38:39], v[10:11]
  v_add_f32 v236, v4, v5
  v_add_f32 v237, v6, v7
  v_add_f32 v238, v8, v9
  v_add_f32 v239, v10, v11
  v_permlane16_swap_b32 v236, v237
  s_nop 0
  v_permlane16_swap_b32 v238, v239
  v_add_f32 v236, v236, v237
  v_add_f32 v238, v238, v239
  s_nop 1
  v_permlane32_swap_b32 v236, v238
  v_add_f32 v236, v236, v238
  ds_write_b32 v233, v236
  s_waitcnt lgkmcnt(0)
  s_barrier
  ds_read_b128 v[44:47], v234 offset:0
  ds_read_b128 v[48:51], v234 offset:256
  ds_read_b128 v[52:55], v234 offset:512
  ds_read_b128 v[56:59], v234 offset:768
  s_waitcnt lgkmcnt(3)
  v_pk_add_f32 v[44:45], v[44:45], v[46:47]
  s_waitcnt lgkmcnt(2)
  v_pk_add_f32 v[48:49], v[48:49], v[50:51]
  s_waitcnt lgkmcnt(1)
  v_pk_add_f32 v[52:53], v[52:53], v[54:55]
  s_waitcnt lgkmcnt(0)
  v_pk_add_f32 v[56:57], v[56:57], v[58:59]
  v_add_f32 v44, v44, v45
  v_add_f32 v48, v48, v49
  v_add_f32 v52, v52, v53
  v_add_f32 v56, v56, v57
  v_mul_f32 v44, 0x3baaaaab, v44
  v_mul_f32 v52, 0x3baaaaab, v52
  v_mul_f32 v45, v44, v44
  v_mul_f32 v53, v52, v52
  v_mul_f32 v48, 0x3baaaaab, v48
  v_mul_f32 v56, 0x3baaaaab, v56
  v_sub_f32 v48, v48, v45
  v_sub_f32 v56, v56, v53
  v_max_f32 v48, 0, v48
  v_max_f32 v56, 0, v56
  v_add_f32 v48, 0x3727c5ac, v48
  v_add_f32 v56, 0x3727c5ac, v56
  v_rsq_f32 v236, v48
  v_rsq_f32 v238, v56
  v_mul_f32 v237, v44, v236
  v_mul_f32 v239, v52, v238
  v_sub_f32 v237, 0, v237
  v_sub_f32 v239, 0, v239
  v_pk_fma_f32 v[16:17], v[16:17], v[236:237], v[236:237] op_sel:[0,0,1] op_sel_hi:[1,0,1]
  v_pk_fma_f32 v[18:19], v[18:19], v[236:237], v[236:237] op_sel:[0,0,1] op_sel_hi:[1,0,1]
  v_pk_fma_f32 v[20:21], v[20:21], v[238:239], v[238:239] op_sel:[0,0,1] op_sel_hi:[1,0,1]
  v_pk_fma_f32 v[22:23], v[22:23], v[238:239], v[238:239] op_sel:[0,0,1] op_sel_hi:[1,0,1]
  v_cvt_pk_bf16_f32 v64, v16, v17
  v_cvt_pk_bf16_f32 v65, v18, v19
  v_cvt_pk_bf16_f32 v66, v20, v21
  v_cvt_pk_bf16_f32 v67, v22, v23
  s_nop 0
  v_permlane16_swap_b32 v64, v66
  v_permlane16_swap_b32 v65, v67
  s_nop 0
  buffer_store_dwordx4 v[64:67], v232, s[44:47], s8 offen sc0 sc1
  v_pk_fma_f32 v[24:25], v[24:25], v[236:237], v[236:237] op_sel:[0,0,1] op_sel_hi:[1,0,1]
  v_pk_fma_f32 v[26:27], v[26:27], v[236:237], v[236:237] op_sel:[0,0,1] op_sel_hi:[1,0,1]
  v_pk_fma_f32 v[28:29], v[28:29], v[238:239], v[238:239] op_sel:[0,0,1] op_sel_hi:[1,0,1]
  v_pk_fma_f32 v[30:31], v[30:31], v[238:239], v[238:239] op_sel:[0,0,1] op_sel_hi:[1,0,1]
  v_cvt_pk_bf16_f32 v68, v24, v25
  v_cvt_pk_bf16_f32 v69, v26, v27
  v_cvt_pk_bf16_f32 v70, v28, v29
  v_cvt_pk_bf16_f32 v71, v30, v31
  s_nop 0
  v_permlane16_swap_b32 v68, v70
  v_permlane16_swap_b32 v69, v71
  s_nop 0
  buffer_store_dwordx4 v[68:71], v232, s[44:47], s9 offen sc0 sc1
  v_pk_fma_f32 v[32:33], v[32:33], v[236:237], v[236:237] op_sel:[0,0,1] op_sel_hi:[1,0,1]
  v_pk_fma_f32 v[34:35], v[34:35], v[236:237], v[236:237] op_sel:[0,0,1] op_sel_hi:[1,0,1]
  v_pk_fma_f32 v[36:37], v[36:37], v[238:239], v[238:239] op_sel:[0,0,1] op_sel_hi:[1,0,1]
  v_pk_fma_f32 v[38:39], v[38:39], v[238:239], v[238:239] op_sel:[0,0,1] op_sel_hi:[1,0,1]
  v_cvt_pk_bf16_f32 v72, v32, v33
  v_cvt_pk_bf16_f32 v73, v34, v35
  v_cvt_pk_bf16_f32 v74, v36, v37
  v_cvt_pk_bf16_f32 v75, v38, v39
  s_nop 0
  v_permlane16_swap_b32 v72, v74
  v_permlane16_swap_b32 v73, v75
  buffer_store_dwordx4 v[72:75], v232, s[44:47], s12 offen sc0 sc1
  s_cmp_lg_u32 s3, 0
  s_cbranch_scc1 k1_noms
  v_add_f32 v44, v44, v14
  v_mul_f32 v45, v48, v236
  v_add_f32 v52, v52, v62
  v_mul_f32_e64 v53, v56, v238
  s_mov_b32 vcc_lo, 0xFFFF0000
  s_mov_b32 vcc_hi, 0xFFFF0000
  v_cndmask_b32 v44, v44, v52, vcc
  v_cndmask_b32 v45, v45, v53, vcc
  s_mov_b32 exec_lo, -1
  s_mov_b32 exec_hi, 0
  buffer_store_dwordx2 v[44:45], v235, s[44:47], s13 offen sc0 sc1
k1_noms:
  s_endpgm
k1_fl0:
  s_mov_b32 s48, s22
  s_mov_b32 s49, s23
  s_mov_b32 s50, 221184
  s_mov_b32 s51, 0x00020000
  s_mov_b32 s52, s24
  s_mov_b32 s53, s25
  s_mov_b32 s54, 73728
  s_mov_b32 s55, 0x00020000
  s_cmp_ge_u32 s15, 72
  s_cselect_b32 s63, 72, 0
  s_sub_u32 s56, s15, s63
  s_mul_i32 s57, s56, 43
  s_lshr_b32 s57, s57, 8
  s_mul_i32 s58, s57, 6
  s_sub_u32 s58, s56, s58
  s_mul_i32 s59, s58, 36864
  s_cmp_ge_u32 s15, 72
  s_cselect_b32 s63, 768, 0
  s_add_u32 s59, s59, s63
  s_add_u32 s60, s59, 4608
  s_lshl_b32 s62, s15, 10
  s_add_u32 s62, s62, 3211264
  v_and_b32 v136, 15, v1
  v_lshrrev_b32 v137, 4, v1
  v_lshrrev_b32 v138, 2, v136
  v_lshlrev_b32 v138, 3, v138
  v_and_b32 v139, 3, v136
  v_add_u32 v138, v138, v139
  v_mul_u32_u24 v139, 1152, v138
.Lk1_pad9:
  s_cbranch_execz k1_retc
  v_lshl_add_u32 v139, v137, 4, v139
  v_mul_u32_u24 v140, 1152, v136
  v_lshl_add_u32 v140, v137, 4, v140
  s_mul_i32 s61, s57, 18432
  s_add_u32 s61, s61, 384
  buffer_load_dwordx4 v[112:115], v140, s[48:51], s61 offen offset:0
  buffer_load_dwordx4 v[116:119], v140, s[48:51], s61 offen offset:64
  buffer_load_dwordx4 v[120:123], v140, s[48:51], s61 offen offset:128
  buffer_load_dwordx4 v[124:127], v140, s[48:51], s61 offen offset:192
  buffer_load_dwordx4 v[128:131], v140, s[48:51], s61 offen offset:256
  buffer_load_dwordx4 v[132:135], v140, s[48:51], s61 offen offset:320
  buffer_load_dwordx4 v[64:67], v139, s[48:51], s59 offen offset:0
  buffer_load_dwordx4 v[88:91], v139, s[48:51], s60 offen offset:0
  buffer_load_dwordx4 v[68:71], v139, s[48:51], s59 offen offset:64
  buffer_load_dwordx4 v[92:95], v139, s[48:51], s60 offen offset:64
  buffer_load_dwordx4 v[72:75], v139, s[48:51], s59 offen offset:128
  buffer_load_dwordx4 v[96:99], v139, s[48:51], s60 offen offset:128
  s_waitcnt vmcnt(18)
  s_barrier
  buffer_load_dwordx4 v[76:79], v139, s[48:51], s59 offen offset:192
  buffer_load_dwordx4 v[100:103], v139, s[48:51], s60 offen offset:192
  buffer_load_dwordx4 v[80:83], v139, s[48:51], s59 offen offset:256
  buffer_load_dwordx4 v[104:107], v139, s[48:51], s60 offen offset:256
  buffer_load_dwordx4 v[84:87], v139, s[48:51], s59 offen offset:320
  buffer_load_dwordx4 v[108:111], v139, s[48:51], s60 offen offset:320
  s_waitcnt vmcnt(18)
  s_barrier
  s_barrier
  s_waitcnt vmcnt(0)
  v_mfma_f32_16x16x32_bf16 v[144:147], v[64:67], v[112:115], 0
  v_mfma_f32_16x16x32_bf16 v[148:151], v[88:91], v[112:115], 0
  v_mfma_f32_16x16x32_bf16 v[144:147], v[68:71], v[116:119], v[144:147]
  v_mfma_f32_16x16x32_bf16 v[148:151], v[92:95], v[116:119], v[148:151]
  v_mfma_f32_16x16x32_bf16 v[144:147], v[72:75], v[120:123], v[144:147]
  v_mfma_f32_16x16x32_bf16 v[148:151], v[96:99], v[120:123], v[148:151]
  v_mfma_f32_16x16x32_bf16 v[144:147], v[76:79], v[124:127], v[144:147]
  v_mfma_f32_16x16x32_bf16 v[148:151], v[100:103], v[124:127], v[148:151]
  v_mfma_f32_16x16x32_bf16 v[144:147], v[80:83], v[128:131], v[144:147]
  v_mfma_f32_16x16x32_bf16 v[148:151], v[104:107], v[128:131], v[148:151]
  v_mfma_f32_16x16x32_bf16 v[144:147], v[84:87], v[132:135], v[144:147]
  v_mfma_f32_16x16x32_bf16 v[148:151], v[108:111], v[132:135], v[148:151]
  s_nop 3
  v_mul_f32 v144, 0x3dd53b95, v144
  v_mul_f32 v145, 0x3dd53b95, v145
  v_mul_f32 v146, 0x3dd53b95, v146
  v_mul_f32 v147, 0x3dd53b95, v147
  v_mul_f32 v148, 0x3dd53b95, v148
  v_mul_f32 v149, 0x3dd53b95, v149
  v_mul_f32 v150, 0x3dd53b95, v150
  v_mul_f32 v151, 0x3dd53b95, v151
  v_cvt_pk_bf16_f32 v136, v144, v145
  v_cvt_pk_bf16_f32 v137, v146, v147
  v_cvt_pk_bf16_f32 v138, v148, v149
  v_cvt_pk_bf16_f32 v139, v150, v151
  buffer_store_dwordx4 v[136:139], v22, s[44:47], s62 offen sc0 sc1
  s_branch k1_ldone
k1_fl1:
  s_mov_b32 s48, s22
  s_mov_b32 s49, s23
  s_mov_b32 s50, 221184
  s_mov_b32 s51, 0x00020000
  s_mov_b32 s52, s24
  s_mov_b32 s53, s25
  s_mov_b32 s54, 73728
  s_mov_b32 s55, 0x00020000
  s_cmp_ge_u32 s15, 72
  s_cselect_b32 s63, 72, 0
  s_sub_u32 s56, s15, s63
  s_mul_i32 s57, s56, 43
  s_lshr_b32 s57, s57, 8
  s_mul_i32 s58, s57, 6
  s_sub_u32 s58, s56, s58
  s_mul_i32 s59, s58, 36864
  s_cmp_ge_u32 s15, 72
  s_cselect_b32 s63, 768, 0
  s_add_u32 s59, s59, s63
  s_add_u32 s60, s59, 4608
  s_lshl_b32 s62, s15, 10
  s_add_u32 s62, s62, 3211264
  v_and_b32 v136, 15, v1
  v_lshrrev_b32 v137, 4, v1
  v_lshrrev_b32 v138, 2, v136
  v_lshlrev_b32 v138, 3, v138
  v_and_b32 v139, 3, v136
  v_add_u32 v138, v138, v139
  v_mul_u32_u24 v139, 1152, v138
  v_lshl_add_u32 v139, v137, 4, v139
  v_mul_u32_u24 v140, 384, v138
  v_lshl_add_u32 v140, v137, 3, v140
  s_lshl_b32 s61, s57, 5
  buffer_load_dwordx2 v[112:113], v140, s[52:55], s61 offen offset:0
  buffer_load_dwordx2 v[114:115], v140, s[52:55], s61 offen offset:1536
  s_add_u32 s61, s61, 12288
  buffer_load_dwordx2 v[116:117], v140, s[52:55], s61 offen offset:0
  buffer_load_dwordx2 v[118:119], v140, s[52:55], s61 offen offset:1536
  s_add_u32 s61, s61, 12288
  buffer_load_dwordx2 v[120:121], v140, s[52:55], s61 offen offset:0
  buffer_load_dwordx2 v[122:123], v140, s[52:55], s61 offen offset:1536
  s_add_u32 s61, s61, 12288
  buffer_load_dwordx2 v[124:125], v140, s[52:55], s61 offen offset:0
  buffer_load_dwordx2 v[126:127], v140, s[52:55], s61 offen offset:1536
  s_add_u32 s61, s61, 12288
  buffer_load_dwordx2 v[128:129], v140, s[52:55], s61 offen offset:0
  buffer_load_dwordx2 v[130:131], v140, s[52:55], s61 offen offset:1536
  s_add_u32 s61, s61, 12288
  buffer_load_dwordx2 v[132:133], v140, s[52:55], s61 offen offset:0
  buffer_load_dwordx2 v[134:135], v140, s[52:55], s61 offen offset:1536
  s_waitcnt vmcnt(18)
  s_barrier
  buffer_load_dwordx4 v[64:67], v139, s[48:51], s59 offen offset:0
  buffer_load_dwordx4 v[88:91], v139, s[48:51], s60 offen offset:0
  buffer_load_dwordx4 v[68:71], v139, s[48:51], s59 offen offset:64
  buffer_load_dwordx4 v[92:95], v139, s[48:51], s60 offen offset:64
  buffer_load_dwordx4 v[72:75], v139, s[48:51], s59 offen offset:128
  buffer_load_dwordx4 v[96:99], v139, s[48:51], s60 offen offset:128
  buffer_load_dwordx4 v[76:79], v139, s[48:51], s59 offen offset:192
  buffer_load_dwordx4 v[100:103], v139, s[48:51], s60 offen offset:192
  buffer_load_dwordx4 v[80:83], v139, s[48:51], s59 offen offset:256
  buffer_load_dwordx4 v[104:107], v139, s[48:51], s60 offen offset:256
  buffer_load_dwordx4 v[84:87], v139, s[48:51], s59 offen offset:320
  buffer_load_dwordx4 v[108:111], v139, s[48:51], s60 offen offset:320
  s_waitcnt vmcnt(24)
  s_barrier
  s_barrier
  s_waitcnt vmcnt(0)
  v_and_b32 v136, 15, v1
  v_lshrrev_b32 v137, 4, v1
  v_lshlrev_b32 v137, 2, v137
  v_sub_u32_e64 v136, v136, v137
  v_mov_b32 v137, 0x3f80
  v_mov_b32 v138, 0x3f800000
  v_cmp_eq_u32 vcc, 0, v136
  s_nop 1
  v_cndmask_b32 v152, 0, v137, vcc
  v_cmp_eq_u32 vcc, 1, v136
  s_nop 1
  v_cndmask_b32 v152, v152, v138, vcc
  v_cmp_eq_u32 vcc, 2, v136
  s_nop 1
  v_cndmask_b32 v153, 0, v137, vcc
  v_cmp_eq_u32 vcc, 3, v136
  s_nop 1
  v_cndmask_b32 v153, v153, v138, vcc
  s_nop 1
  v_mfma_f32_16x16x16_bf16 v[156:159], v[112:113], v[152:153], 0
  v_mfma_f32_16x16x16_bf16 v[160:163], v[114:115], v[152:153], 0
  v_mfma_f32_16x16x16_bf16 v[164:167], v[116:117], v[152:153], 0
  v_mfma_f32_16x16x16_bf16 v[168:171], v[118:119], v[152:153], 0
  v_mfma_f32_16x16x16_bf16 v[172:175], v[120:121], v[152:153], 0
  v_mfma_f32_16x16x16_bf16 v[176:179], v[122:123], v[152:153], 0
  v_mfma_f32_16x16x16_bf16 v[180:183], v[124:125], v[152:153], 0
  v_mfma_f32_16x16x16_bf16 v[184:187], v[126:127], v[152:153], 0
  v_mfma_f32_16x16x16_bf16 v[188:191], v[128:129], v[152:153], 0
.Lk1_pad10:
  s_cbranch_execz k1_retc
  s_nop 0
  v_mfma_f32_16x16x16_bf16 v[192:195], v[130:131], v[152:153], 0
  v_mfma_f32_16x16x16_bf16 v[196:199], v[132:133], v[152:153], 0
  v_mfma_f32_16x16x16_bf16 v[200:203], v[134:135], v[152:153], 0
  v_cvt_pk_bf16_f32 v112, v156, v157
  v_cvt_pk_bf16_f32 v113, v158, v159
  v_cvt_pk_bf16_f32 v114, v160, v161
  v_cvt_pk_bf16_f32 v115, v162, v163
  v_cvt_pk_bf16_f32 v116, v164, v165
  v_cvt_pk_bf16_f32 v117, v166, v167
  v_cvt_pk_bf16_f32 v118, v168, v169
  v_cvt_pk_bf16_f32 v119, v170, v171
  v_cvt_pk_bf16_f32 v120, v172, v173
  v_cvt_pk_bf16_f32 v121, v174, v175
  v_cvt_pk_bf16_f32 v122, v176, v177
  v_cvt_pk_bf16_f32 v123, v178, v179
  v_cvt_pk_bf16_f32 v124, v180, v181
  v_cvt_pk_bf16_f32 v125, v182, v183
  v_cvt_pk_bf16_f32 v126, v184, v185
  v_cvt_pk_bf16_f32 v127, v186, v187
  v_cvt_pk_bf16_f32 v128, v188, v189
  v_cvt_pk_bf16_f32 v129, v190, v191
  v_cvt_pk_bf16_f32 v130, v192, v193
  v_cvt_pk_bf16_f32 v131, v194, v195
  v_cvt_pk_bf16_f32 v132, v196, v197
  v_cvt_pk_bf16_f32 v133, v198, v199
  v_cvt_pk_bf16_f32 v134, v200, v201
  v_cvt_pk_bf16_f32 v135, v202, v203
  v_mfma_f32_16x16x32_bf16 v[144:147], v[64:67], v[112:115], 0
  v_mfma_f32_16x16x32_bf16 v[148:151], v[88:91], v[112:115], 0
  v_mfma_f32_16x16x32_bf16 v[144:147], v[68:71], v[116:119], v[144:147]
  v_mfma_f32_16x16x32_bf16 v[148:151], v[92:95], v[116:119], v[148:151]
  v_mfma_f32_16x16x32_bf16 v[144:147], v[72:75], v[120:123], v[144:147]
  v_mfma_f32_16x16x32_bf16 v[148:151], v[96:99], v[120:123], v[148:151]
  v_mfma_f32_16x16x32_bf16 v[144:147], v[76:79], v[124:127], v[144:147]
  v_mfma_f32_16x16x32_bf16 v[148:151], v[100:103], v[124:127], v[148:151]
  v_mfma_f32_16x16x32_bf16 v[144:147], v[80:83], v[128:131], v[144:147]
  v_mfma_f32_16x16x32_bf16 v[148:151], v[104:107], v[128:131], v[148:151]
  v_mfma_f32_16x16x32_bf16 v[144:147], v[84:87], v[132:135], v[144:147]
  v_mfma_f32_16x16x32_bf16 v[148:151], v[108:111], v[132:135], v[148:151]
  s_nop 3
  v_cvt_pk_bf16_f32 v136, v144, v145
  v_cvt_pk_bf16_f32 v137, v146, v147
  s_nop 1
  v_cvt_pk_bf16_f32 v138, v148, v149
  v_cvt_pk_bf16_f32 v139, v150, v151
  buffer_store_dwordx4 v[136:139], v22, s[44:47], s62 offen sc0 sc1
  s_branch k1_ldone

.p2align 10
.globl k2_kernel
.p2align 8
.type k2_kernel,@function
k2_kernel:
.Lk2_apad0:
  s_cbranch_execz k1_warm0
  s_cmp_ge_u32 s2, 256
  s_cbranch_scc1 k2_exit
  s_load_dwordx16 s[16:31], s[0:1], 0
  v_lshrrev_b32 v2, 6, v0
  s_nop 0
  v_readfirstlane_b32 s3, v2
  s_and_b32 s4, s2, 7
  s_lshr_b32 s5, s2, 3
  s_mov_b32 s44, 0
  s_mov_b32 s40, 49152
  s_mov_b32 s41, 4294868992
  s_mov_b32 s49, 0x00400000
  s_cmp_lt_u32 s3, 4
  s_cbranch_scc1 k2_cstart
  s_sub_u32 s7, s3, 4
k2_lstart:
  v_mbcnt_lo_u32_b32 v1, -1, 0
  v_mbcnt_hi_u32_b32 v1, -1, v1
  v_lshlrev_b32 v2, 4, v1
  s_mul_i32 s10, s4, 393216
  s_add_u32 s11, s5, s7
  s_mul_i32 s12, s7, 12288
  s_lshl_b32 s8, s7, 9
  s_add_u32 s50, s8, 161152
  s_mov_b32 s51, 3358720
  v_and_b32 v3, 31, v1
  v_lshlrev_b32 v3, 2, v3
  v_add_u32 v3, s50, v3
  v_mov_b32 v4, 0
  ds_write_b32 v3, v4
  s_mul_i32 s60, s7, 18432
  s_add_u32 s60, s60, 3284992
  s_add_u32 s61, s60, 4096
  s_add_u32 s62, s60, 8192
  s_add_u32 s63, s60, 12288
  s_waitcnt lgkmcnt(0)
  s_mov_b32 s32, s30
  s_mov_b32 s33, s31
  s_mov_b32 s34, 268435456
  s_mov_b32 s35, 0x00020000
  s_and_b32 s11, s11, 31
  s_mul_i32 s13, s11, 12288
  s_add_u32 s13, s13, s10
  s_add_u32 s11, s11, 4
  s_add_u32 m0, s12, 0
  s_nop 0
  buffer_load_dwordx4 v2, s[32:35], s13 offen offset:0 lds
  buffer_load_dwordx4 v2, s[32:35], s13 offen offset:1024 lds
  buffer_load_dwordx4 v2, s[32:35], s13 offen offset:2048 lds
  buffer_load_dwordx4 v2, s[32:35], s13 offen offset:3072 lds
  s_add_u32 s13, s13, 4096
  s_add_u32 m0, s12, 4096
  s_nop 0
  buffer_load_dwordx4 v2, s[32:35], s13 offen offset:0 lds
  buffer_load_dwordx4 v2, s[32:35], s13 offen offset:1024 lds
  buffer_load_dwordx4 v2, s[32:35], s13 offen offset:2048 lds
  buffer_load_dwordx4 v2, s[32:35], s13 offen offset:3072 lds
  s_add_u32 s13, s13, 4096
  s_add_u32 m0, s12, 8192
  s_nop 0
  buffer_load_dwordx4 v2, s[32:35], s13 offen offset:0 lds
  buffer_load_dwordx4 v2, s[32:35], s13 offen offset:1024 lds
  buffer_load_dwordx4 v2, s[32:35], s13 offen offset:2048 lds
  buffer_load_dwordx4 v2, s[32:35], s13 offen offset:3072 lds
  s_mov_b32 m0, s50
  s_mov_b32 exec_hi, 0
  buffer_load_dword v4, s[32:35], s51 offen lds
  s_mov_b32 exec_hi, -1
  s_add_u32 s51, s51, 4
  s_add_u32 s12, s12, 49152
  s_barrier
  s_barrier
  s_barrier
  s_barrier
  buffer_load_dwordx4 v[64:67], v2, s[32:35], s60 offen offset:0
  buffer_load_dwordx4 v[88:91], v2, s[32:35], s61 offen offset:2048
  buffer_load_dwordx4 v[112:115], v2, s[32:35], s63 offen offset:0
  buffer_load_dwordx4 v[68:71], v2, s[32:35], s60 offen offset:1024
  buffer_load_dwordx4 v[92:95], v2, s[32:35], s61 offen offset:3072
  buffer_load_dwordx4 v[116:119], v2, s[32:35], s63 offen offset:1024
  s_and_b32 s11, s11, 31
  s_mul_i32 s13, s11, 12288
  s_add_u32 s13, s13, s10
  s_add_u32 s11, s11, 4
  s_add_u32 m0, s12, 0
  s_nop 0
  buffer_load_dwordx4 v2, s[32:35], s13 offen offset:0 lds
  buffer_load_dwordx4 v2, s[32:35], s13 offen offset:1024 lds
  buffer_load_dwordx4 v2, s[32:35], s13 offen offset:2048 lds
  buffer_load_dwordx4 v2, s[32:35], s13 offen offset:3072 lds
  s_add_u32 s13, s13, 4096
  s_add_u32 m0, s12, 4096
  s_nop 0
  buffer_load_dwordx4 v2, s[32:35], s13 offen offset:0 lds
  buffer_load_dwordx4 v2, s[32:35], s13 offen offset:1024 lds
  buffer_load_dwordx4 v2, s[32:35], s13 offen offset:2048 lds
  buffer_load_dwordx4 v2, s[32:35], s13 offen offset:3072 lds
  s_add_u32 s13, s13, 4096
  s_add_u32 m0, s12, 8192
  s_nop 0
  buffer_load_dwordx4 v2, s[32:35], s13 offen offset:0 lds
  buffer_load_dwordx4 v2, s[32:35], s13 offen offset:1024 lds
  buffer_load_dwordx4 v2, s[32:35], s13 offen offset:2048 lds
  buffer_load_dwordx4 v2, s[32:35], s13 offen offset:3072 lds
  s_mov_b32 m0, s50
  s_mov_b32 exec_hi, 0
  buffer_load_dword v4, s[32:35], s51 offen lds
  s_mov_b32 exec_hi, -1
  s_add_u32 s51, s51, 4
  s_add_u32 s12, s12, 49152
  s_and_b32 s11, s11, 31
  s_mul_i32 s13, s11, 12288
  s_add_u32 s13, s13, s10
  s_add_u32 s11, s11, 4
  s_add_u32 m0, s12, 0
  s_nop 0
  buffer_load_dwordx4 v2, s[32:35], s13 offen offset:0 lds
  buffer_load_dwordx4 v2, s[32:35], s13 offen offset:1024 lds
  buffer_load_dwordx4 v2, s[32:35], s13 offen offset:2048 lds
  buffer_load_dwordx4 v2, s[32:35], s13 offen offset:3072 lds
  s_add_u32 s13, s13, 4096
  s_add_u32 m0, s12, 4096
  s_nop 0
  buffer_load_dwordx4 v2, s[32:35], s13 offen offset:0 lds
  buffer_load_dwordx4 v2, s[32:35], s13 offen offset:1024 lds
  buffer_load_dwordx4 v2, s[32:35], s13 offen offset:2048 lds
  buffer_load_dwordx4 v2, s[32:35], s13 offen offset:3072 lds
  s_add_u32 s13, s13, 4096
  s_add_u32 m0, s12, 8192
  s_nop 0
  buffer_load_dwordx4 v2, s[32:35], s13 offen offset:0 lds
  buffer_load_dwordx4 v2, s[32:35], s13 offen offset:1024 lds
  buffer_load_dwordx4 v2, s[32:35], s13 offen offset:2048 lds
  buffer_load_dwordx4 v2, s[32:35], s13 offen offset:3072 lds
  s_mov_b32 m0, s50
  s_mov_b32 exec_hi, 0
  buffer_load_dword v4, s[32:35], s51 offen lds
  s_mov_b32 exec_hi, -1
  s_add_u32 s51, s51, 4
  s_add_u32 s12, s12, 4294868992
  s_branch k2_loader2
k2_cstart:
  v_mbcnt_lo_u32_b32 v7, -1, 0
  v_mbcnt_hi_u32_b32 v7, -1, v7
  v_and_b32 v5, 31, v7
  v_lshlrev_b32_e64 v5, 2, v5
  v_add_u32 v187, 161152, v5
  s_lshl_b32 s11, s3, 9
  s_add_u32 s11, s11, 160768
  v_add_u32 v5, s11, v5
  v_mov_b32_e64 v4, 0
  v_mov_b32 v184, 163332
  ds_write_b32 v184, v4
  v_lshlrev_b32 v186, 4, v7
  v_lshlrev_b32 v6, 3, v7
  v_and_b32 v204, 15, v7
  v_add_u32 v203, 4, v204
  v_cmp_gt_u32 vcc, 4, v204
  s_nop 1
  v_cndmask_b32 v203, v203, v204, vcc
  v_subrev_u32 v205, 8, v204
  v_cmp_lt_u32 vcc, 11, v204
  s_nop 1
  v_cndmask_b32 v203, v203, v205, vcc
  v_lshrrev_b32 v204, 4, v7
  v_lshlrev_b32 v206, 2, v204
  v_xor_b32 v206, v206, v203
.Lk2_pad0:
  s_cbranch_execz .Lk2_pad3
  v_lshlrev_b32 v206, 4, v206
  v_lshl_add_u32 v206, v204, 9, v206
  s_mul_i32 s9, s3, 6
  v_lshrrev_b32 v204, 5, v7
  v_add_u32 v204, s9, v204
  v_add_u32 v205, 0, v204
  v_and_b32 v200, 3, v205
  v_lshlrev_b32 v200, 2, v200
  v_xor_b32 v200, v200, v203
  v_lshlrev_b32 v200, 4, v200
  v_lshl_add_u32 v200, v205, 9, v200
  v_bfe_u32 v205, v7, 4, 1
  v_lshl_add_u32 v200, v205, 3, v200
  v_add_u32 v200, 147456, v200
  v_add_u32 v205, 2, v204
  v_and_b32 v201, 3, v205
  v_lshlrev_b32 v201, 2, v201
  v_xor_b32 v201, v201, v203
  v_lshlrev_b32_e64 v201, 4, v201
  v_lshl_add_u32 v201, v205, 9, v201
  v_bfe_u32 v205, v7, 4, 1
  v_lshl_add_u32 v201, v205, 3, v201
  v_add_u32 v201, 147456, v201
  v_add_u32 v205, 4, v204
  v_and_b32 v202, 3, v205
  v_lshlrev_b32 v202, 2, v202
  v_xor_b32 v202, v202, v203
  v_lshlrev_b32_e64 v202, 4, v202
  v_lshl_add_u32 v202, v205, 9, v202
  v_bfe_u32 v205, v7, 4, 1
  v_lshl_add_u32 v202, v205, 3, v202
  v_add_u32 v202, 147456, v202
  s_mul_i32 s52, s3, 12288
  v_and_b32 v204, 31, v7
  v_lshrrev_b32 v205, 5, v7
  v_lshlrev_b32 v207, 2, v205
  v_xor_b32 v207, v207, v204
  v_lshlrev_b32_e64 v207, 4, v207
  v_lshl_add_u32 v0, v205, 9, v207
  v_add_u32_e64 v0, s52, v0
  v_xor_b32 v1, 128, v0
  v_bfe_u32 v207, v7, 4, 1
  v_bfe_u32 v3, v7, 1, 1
  v_lshl_add_u32 v207, v207, 1, v3
  v_add_u32 v207, s3, v207
  v_and_b32 v207, 3, v207
  v_bfe_u32 v3, v7, 2, 2
  v_lshl_add_u32 v3, v205, 2, v3
  v_lshlrev_b32 v204, 2, v207
  v_xor_b32 v3, v3, v204
  v_lshlrev_b32_e64 v3, 4, v3
  v_lshl_add_u32 v2, v207, 9, v3
  v_and_b32_e64 v204, 1, v7
  v_lshl_add_u32 v2, v204, 3, v2
  v_add_u32_e64 v2, s52, v2
  v_xor_b32 v3, 128, v2
  v_mov_b32 v8, 0
  v_mov_b32 v9, 0
  v_mov_b32 v10, 0
  v_mov_b32 v11, 0
  v_mov_b32 v12, 0
  v_mov_b32 v13, 0
  v_mov_b32 v14, 0
  v_mov_b32 v15, 0
  v_mov_b32 v16, 0
  v_mov_b32 v17, 0
  v_mov_b32 v18, 0
  v_mov_b32 v19, 0
  v_mov_b32 v20, 0
  v_mov_b32 v21, 0
  v_mov_b32 v22, 0
  v_mov_b32 v23, 0
  v_mov_b32 v24, 0
  v_mov_b32 v25, 0
  v_mov_b32 v26, 0
  v_mov_b32 v27, 0
  v_mov_b32 v28, 0
  v_mov_b32 v29, 0
  v_mov_b32 v30, 0
  v_mov_b32 v31, 0
  v_mov_b32 v32, 0
  v_mov_b32 v33, 0
  v_mov_b32 v34, 0
  v_mov_b32 v35, 0
  v_mov_b32 v36, 0
  v_mov_b32 v37, 0
  v_mov_b32 v38, 0
  v_mov_b32 v39, 0
  v_mov_b32 v40, 0
  v_mov_b32 v41, 0
  v_mov_b32 v42, 0
  v_mov_b32 v43, 0
  v_mov_b32 v44, 0
  v_mov_b32 v45, 0
  v_mov_b32 v46, 0
  v_mov_b32 v47, 0
  v_mov_b32 v48, 0
  v_mov_b32 v49, 0
  v_mov_b32 v50, 0
  v_mov_b32 v51, 0
  v_mov_b32 v52, 0
  v_mov_b32 v53, 0
  v_mov_b32 v54, 0
  v_mov_b32 v55, 0
  v_mov_b32 v56, 0
  v_mov_b32 v57, 0
  v_mov_b32 v58, 0
  v_mov_b32 v59, 0
  v_mov_b32 v60, 0
  v_mov_b32 v61, 0
  v_mov_b32 v62, 0
  v_mov_b32 v63, 0
  v_mov_b32 v64, 0
  v_mov_b32 v65, 0
  v_mov_b32 v66, 0
  v_mov_b32 v67, 0
  v_mov_b32 v68, 0
  v_mov_b32 v69, 0
  v_mov_b32 v70, 0
  v_mov_b32 v71, 0
  v_mov_b32 v72, 0
  v_mov_b32 v73, 0
  v_mov_b32 v74, 0
  v_mov_b32 v75, 0
  v_mov_b32 v76, 0
  v_mov_b32 v77, 0
  v_mov_b32 v78, 0
  v_mov_b32 v79, 0
  v_mov_b32 v80, 0
  v_mov_b32 v81, 0
  v_mov_b32 v82, 0
  v_mov_b32 v83, 0
  v_mov_b32 v84, 0
  v_mov_b32 v85, 0
  v_mov_b32 v86, 0
  v_mov_b32 v87, 0
  v_mov_b32 v88, 0
  v_mov_b32 v89, 0
  v_mov_b32 v90, 0
  v_mov_b32 v91, 0
  v_mov_b32 v92, 0
  v_mov_b32 v93, 0
  v_mov_b32 v94, 0
  v_mov_b32 v95, 0
  v_mov_b32 v96, 0
  v_mov_b32 v97, 0
  v_mov_b32 v98, 0
  v_mov_b32 v99, 0
  v_mov_b32 v100, 0
  v_mov_b32 v101, 0
  v_mov_b32 v102, 0
  v_mov_b32 v103, 0
  s_mov_b32 s43, 1
  s_mov_b32 s42, 49152
  s_mov_b32 s48, 1
  s_sub_u32 s8, s3, 1
  s_and_b32 s8, s8, 3
  s_mul_i32 s53, s8, 12288
  s_sub_u32 s8, s3, 2
  s_and_b32 s8, s8, 3
  s_mul_i32 s54, s8, 12288
  s_sub_u32 s8, s3, 3
  s_and_b32 s8, s8, 3
  s_mul_i32 s55, s8, 12288
  s_lshl_b32 s56, s3, 9
  s_add_u32 s56, s56, 147456
  s_lshl_b32 s57, s3, 2
  s_lshl_b32 s58, s3, 3
  s_add_u32 s58, s58, 159744
  s_mov_b32 s59, 159744
  s_mul_i32 s8, s3, 18432
  s_add_u32 s8, s8, 3211264
  s_add_u32 s9, s8, 6144
  s_add_u32 s10, s8, 12288
  s_waitcnt lgkmcnt(0)
  s_mov_b32 s32, s30
  s_mov_b32 s33, s31
  s_mov_b32 s34, 268435456
  s_mov_b32 s35, 0x00020000
  s_barrier
  s_barrier
  s_barrier
  buffer_load_dwordx4 v[104:107], v186, s[32:35], s8 offen offset:0
  buffer_load_dwordx4 v[108:111], v186, s[32:35], s9 offen offset:0
  buffer_load_dwordx4 v[112:115], v186, s[32:35], s10 offen offset:0
  buffer_load_dwordx4 v[116:119], v186, s[32:35], s8 offen offset:1024
  buffer_load_dwordx4 v[120:123], v186, s[32:35], s9 offen offset:1024
  buffer_load_dwordx4 v[124:127], v186, s[32:35], s10 offen offset:1024
  buffer_load_dwordx4 v[128:131], v186, s[32:35], s8 offen offset:2048
  buffer_load_dwordx4 v[132:135], v186, s[32:35], s9 offen offset:2048
  buffer_load_dwordx4 v[136:139], v186, s[32:35], s10 offen offset:2048
  buffer_load_dwordx4 v[140:143], v186, s[32:35], s8 offen offset:3072
  buffer_load_dwordx4 v[144:147], v186, s[32:35], s9 offen offset:3072
  buffer_load_dwordx4 v[148:151], v186, s[32:35], s10 offen offset:3072
  s_add_u32 s8, s8, 4096
  s_add_u32 s9, s9, 4096
  s_add_u32 s10, s10, 4096
.Lk2_pad1:
  s_cbranch_execz .Lk2_pad4
  buffer_load_dwordx4 v[232:235], v186, s[32:35], s8 offen offset:0
  buffer_load_dwordx4 v[236:239], v186, s[32:35], s9 offen offset:0
  buffer_load_dwordx4 v[240:243], v186, s[32:35], s10 offen offset:0
  buffer_load_dwordx4 v[244:247], v186, s[32:35], s8 offen offset:1024
  buffer_load_dwordx4 v[248:251], v186, s[32:35], s9 offen offset:1024
  buffer_load_dwordx4 v[252:255], v186, s[32:35], s10 offen offset:1024
  s_barrier
k2_opoll:
  s_sub_u32 s49, s49, 1
  s_cbranch_scc1 k2_exit
  ds_read_b32 v205, v187
  s_waitcnt lgkmcnt(0)
  v_cmp_gt_u32 vcc, 1, v205
  s_nop 0
  s_cbranch_vccnz k2_opoll
  v_mov_b32 v207, 163332
  ds_read_b128 v[152:155], v206 offset:0
  ds_read_b128 v[156:159], v206 offset:256
  ds_read_b128 v[160:163], v206 offset:2048
  ds_read_b128 v[164:167], v206 offset:2304
  ds_read_b128 v[168:171], v206 offset:4096
  ds_read_b128 v[172:175], v206 offset:4352
  ds_read_b128 v[176:179], v206 offset:6144
  ds_read_b128 v[180:183], v206 offset:6400
  ds_read_b128 v[184:187], v206 offset:8192
  ds_read_b128 v[188:191], v206 offset:8448
  ds_read_b128 v[192:195], v206 offset:10240
  ds_read_b128 v[196:199], v206 offset:10496
  s_waitcnt vmcnt(17) lgkmcnt(11)
  v_mfma_f32_16x16x32_bf16 v[208:211], v[104:107], v[152:155], 0
  s_waitcnt lgkmcnt(10)
  v_mfma_f32_16x16x32_bf16 v[212:215], v[104:107], v[156:159], 0
  s_waitcnt vmcnt(16)
  v_mfma_f32_16x16x32_bf16 v[216:219], v[108:111], v[152:155], 0
  v_mfma_f32_16x16x32_bf16 v[220:223], v[108:111], v[156:159], 0
  s_waitcnt vmcnt(15)
  v_mfma_f32_16x16x32_bf16 v[224:227], v[112:115], v[152:155], 0
  v_mfma_f32_16x16x32_bf16 v[228:231], v[112:115], v[156:159], 0
  s_waitcnt vmcnt(14) lgkmcnt(9)
  v_mfma_f32_16x16x32_bf16 v[208:211], v[116:119], v[160:163], v[208:211]
  s_waitcnt lgkmcnt(8)
  v_mfma_f32_16x16x32_bf16 v[212:215], v[116:119], v[164:167], v[212:215]
  s_waitcnt vmcnt(13)
  v_mfma_f32_16x16x32_bf16 v[216:219], v[120:123], v[160:163], v[216:219]
  v_mfma_f32_16x16x32_bf16 v[220:223], v[120:123], v[164:167], v[220:223]
  s_waitcnt vmcnt(12)
  v_mfma_f32_16x16x32_bf16 v[224:227], v[124:127], v[160:163], v[224:227]
  v_mfma_f32_16x16x32_bf16 v[228:231], v[124:127], v[164:167], v[228:231]
  s_waitcnt vmcnt(11) lgkmcnt(7)
  v_mfma_f32_16x16x32_bf16 v[208:211], v[128:131], v[168:171], v[208:211]
  s_waitcnt lgkmcnt(6)
  v_mfma_f32_16x16x32_bf16 v[212:215], v[128:131], v[172:175], v[212:215]
  s_waitcnt vmcnt(10)
  v_mfma_f32_16x16x32_bf16 v[216:219], v[132:135], v[168:171], v[216:219]
  v_mfma_f32_16x16x32_bf16 v[220:223], v[132:135], v[172:175], v[220:223]
  s_waitcnt vmcnt(9)
  v_mfma_f32_16x16x32_bf16 v[224:227], v[136:139], v[168:171], v[224:227]
  v_mfma_f32_16x16x32_bf16 v[228:231], v[136:139], v[172:175], v[228:231]
  s_waitcnt vmcnt(8) lgkmcnt(5)
  v_mfma_f32_16x16x32_bf16 v[208:211], v[140:143], v[176:179], v[208:211]
  s_waitcnt lgkmcnt(4)
  v_mfma_f32_16x16x32_bf16 v[212:215], v[140:143], v[180:183], v[212:215]
  s_waitcnt vmcnt(7)
  v_mfma_f32_16x16x32_bf16 v[216:219], v[144:147], v[176:179], v[216:219]
  v_mfma_f32_16x16x32_bf16 v[220:223], v[144:147], v[180:183], v[220:223]
  s_waitcnt vmcnt(6)
  v_mfma_f32_16x16x32_bf16 v[224:227], v[148:151], v[176:179], v[224:227]
  v_mfma_f32_16x16x32_bf16 v[228:231], v[148:151], v[180:183], v[228:231]
  s_waitcnt vmcnt(5) lgkmcnt(3)
  v_mfma_f32_16x16x32_bf16 v[208:211], v[232:235], v[184:187], v[208:211]
  s_waitcnt lgkmcnt(2)
  v_mfma_f32_16x16x32_bf16 v[212:215], v[232:235], v[188:191], v[212:215]
  s_waitcnt vmcnt(4)
  v_mfma_f32_16x16x32_bf16 v[216:219], v[236:239], v[184:187], v[216:219]
  v_mfma_f32_16x16x32_bf16 v[220:223], v[236:239], v[188:191], v[220:223]
  s_waitcnt vmcnt(3)
  v_mfma_f32_16x16x32_bf16 v[224:227], v[240:243], v[184:187], v[224:227]
  v_mfma_f32_16x16x32_bf16 v[228:231], v[240:243], v[188:191], v[228:231]
  s_waitcnt vmcnt(2) lgkmcnt(1)
  v_mfma_f32_16x16x32_bf16 v[208:211], v[244:247], v[192:195], v[208:211]
  s_waitcnt lgkmcnt(0)
  v_mfma_f32_16x16x32_bf16 v[212:215], v[244:247], v[196:199], v[212:215]
  s_waitcnt vmcnt(1)
  v_mfma_f32_16x16x32_bf16 v[216:219], v[248:251], v[192:195], v[216:219]
  v_mfma_f32_16x16x32_bf16 v[220:223], v[248:251], v[196:199], v[220:223]
  s_waitcnt vmcnt(0)
  s_nop 0
  v_mfma_f32_16x16x32_bf16 v[224:227], v[252:255], v[192:195], v[224:227]
  v_mfma_f32_16x16x32_bf16 v[228:231], v[252:255], v[196:199], v[228:231]
  v_cvt_pk_bf16_f32 v208, v208, v209
  v_cvt_pk_bf16_f32 v209, v210, v211
  ds_write_b64 v200, v[208:209] offset:0
  v_cvt_pk_bf16_f32 v212, v212, v213
  v_cvt_pk_bf16_f32 v213, v214, v215
  ds_write_b64 v200, v[212:213] offset:256
  v_cvt_pk_bf16_f32 v216, v216, v217
  v_cvt_pk_bf16_f32 v217, v218, v219
  ds_write_b64 v201, v[216:217] offset:0
  v_cvt_pk_bf16_f32 v220, v220, v221
  v_cvt_pk_bf16_f32 v221, v222, v223
  ds_write_b64 v201, v[220:221] offset:256
  v_cvt_pk_bf16_f32 v224, v224, v225
  v_cvt_pk_bf16_f32 v225, v226, v227
  ds_write_b64 v202, v[224:225] offset:0
  v_cvt_pk_bf16_f32 v228, v228, v229
  v_cvt_pk_bf16_f32 v229, v230, v231
  ds_write_b64 v202, v[228:229] offset:256
  v_mov_b32 v205, 1
  s_mov_b64 exec, 1
  ds_add_u32 v207, v205
  s_mov_b64 exec, -1
  s_sub_u32 s8, 147456, s52
  v_add_u32 v184, s8, v0
  v_add_u32 v185, s8, v1
k2_qpoll:
  s_sub_u32 s49, s49, 1
  s_cbranch_scc1 k2_exit
  ds_read_b32 v205, v207
  ds_read_b32 v7, v5 offset:384
  s_waitcnt lgkmcnt(1)
  v_cmp_gt_u32 vcc, 4, v205
  s_waitcnt lgkmcnt(0)
  v_cmp_gt_u32 s[8:9], s48, v7
  s_or_b64 vcc, vcc, s[8:9]
  s_cbranch_vccnz k2_qpoll
  ds_read_b128 v[104:107], v184 offset:0
  ds_read_b128 v[192:195], v0 offset:0
  ds_read_b128 v[108:111], v185 offset:1024
  ds_read_b128 v[196:199], v1 offset:1024
  ds_read_b128 v[112:115], v184 offset:2048
  ds_read_b128 v[200:203], v0 offset:2048
  ds_read_b128 v[116:119], v185 offset:3072
  ds_read_b128 v[204:207], v1 offset:3072
  ds_read_b128 v[120:123], v184 offset:4096
  ds_read_b128 v[124:127], v185 offset:5120
  ds_read_b128 v[128:131], v184 offset:6144
  ds_read_b128 v[132:135], v185 offset:7168
  ds_read_b128 v[136:139], v184 offset:8192
  ds_read_b128 v[140:143], v185 offset:9216
  ds_read_b128 v[144:147], v184 offset:10240
  ds_read_b128 v[148:151], v185 offset:11264
  s_mov_b32 s48, 2
  s_cmp_lg_u32 s44, 0
  s_cbranch_scc1 k2_slow
  s_waitcnt lgkmcnt(14)
  v_mfma_f32_32x32x16_bf16 v[152:167], v[192:195], v[104:107], 0
  ds_read_b128 v[192:195], v0 offset:4096
  ds_read_b64_tr_b16 v[208:209], v2 offset:0
  ds_read_b64_tr_b16 v[210:211], v2 offset:256
  s_waitcnt lgkmcnt(15)
  v_mfma_f32_32x32x16_bf16 v[152:167], v[196:199], v[108:111], v[152:167]
  ds_read_b128 v[196:199], v1 offset:5120
  ds_read_b64_tr_b16 v[212:213], v3 offset:0
  ds_read_b64_tr_b16 v[214:215], v3 offset:256
.Lk2_pad2:
  s_cbranch_execz .Lk2_pad5
  s_waitcnt lgkmcnt(15)
  v_mfma_f32_32x32x16_bf16 v[152:167], v[200:203], v[112:115], v[152:167]
  ds_read_b128 v[200:203], v0 offset:6144
  ds_read_b64_tr_b16 v[216:217], v2 offset:2048
  ds_read_b64_tr_b16 v[218:219], v2 offset:2304
  s_waitcnt lgkmcnt(15)
  v_mfma_f32_32x32x16_bf16 v[152:167], v[204:207], v[116:119], v[152:167]
  ds_read_b128 v[204:207], v1 offset:7168
  ds_read_b64_tr_b16 v[220:221], v3 offset:2048
  ds_read_b64_tr_b16 v[222:223], v3 offset:2304
  s_waitcnt lgkmcnt(11)
  v_mfma_f32_32x32x16_bf16 v[152:167], v[192:195], v[120:123], v[152:167]
  ds_read_b128 v[192:195], v0 offset:8192
  ds_read_b64_tr_b16 v[224:225], v2 offset:4096
  ds_read_b64_tr_b16 v[226:227], v2 offset:4352
  s_waitcnt lgkmcnt(11)
  v_mfma_f32_32x32x16_bf16 v[152:167], v[196:199], v[124:127], v[152:167]
  ds_read_b128 v[196:199], v1 offset:9216
  ds_read_b64_tr_b16 v[228:229], v3 offset:4096
  ds_read_b64_tr_b16 v[230:231], v3 offset:4352
  ds_read_b32 v7, v5 offset:384
  s_waitcnt lgkmcnt(12)
  v_mfma_f32_32x32x16_bf16 v[152:167], v[200:203], v[128:131], v[152:167]
  ds_read_b128 v[200:203], v0 offset:10240
  ds_read_b64_tr_b16 v[232:233], v2 offset:6144
  ds_read_b64_tr_b16 v[234:235], v2 offset:6400
  s_waitcnt lgkmcnt(12)
  v_mfma_f32_32x32x16_bf16 v[152:167], v[204:207], v[132:135], v[152:167]
  ds_read_b128 v[204:207], v1 offset:11264
  ds_read_b64_tr_b16 v[236:237], v3 offset:6144
  ds_read_b64_tr_b16 v[238:239], v3 offset:6400
  v_add_u32 v0, s42, v0
  v_add_u32 v1, s42, v1
  s_waitcnt lgkmcnt(6)
  v_cmp_gt_u32 vcc, s48, v7
  s_nop 0
  s_cbranch_vccnz k2_poll0
k2_back0:
  v_mfma_f32_32x32x16_bf16 v[152:167], v[192:195], v[136:139], v[152:167]
  ds_read_b128 v[192:195], v0 offset:0
  ds_read_b64_tr_b16 v[240:241], v2 offset:8192
  ds_read_b64_tr_b16 v[242:243], v2 offset:8448
  v_mfma_f32_32x32x16_bf16 v[152:167], v[196:199], v[140:143], v[152:167]
  ds_read_b128 v[196:199], v1 offset:1024
  ds_read_b64_tr_b16 v[244:245], v3 offset:8192
  ds_read_b64_tr_b16 v[246:247], v3 offset:8448
  s_waitcnt lgkmcnt(11)
  v_mfma_f32_32x32x16_bf16 v[152:167], v[200:203], v[144:147], v[152:167]
  ds_read_b128 v[200:203], v0 offset:2048
  ds_read_b64_tr_b16 v[248:249], v2 offset:10240
  ds_read_b64_tr_b16 v[250:251], v2 offset:10496
  s_waitcnt lgkmcnt(11)
  v_mfma_f32_32x32x16_bf16 v[152:167], v[204:207], v[148:151], v[152:167]
  ds_read_b64_tr_b16 v[252:253], v3 offset:10240
  ds_read_b64_tr_b16 v[254:255], v3 offset:10496
  ds_read_b128 v[204:207], v1 offset:3072
  s_waitcnt lgkmcnt(11)
  v_mfma_f32_32x32x16_bf16 v[168:183], v[192:195], v[104:107], 0
  ds_read_b128 v[192:195], v0 offset:4096
  s_waitcnt lgkmcnt(9)
  v_mfma_f32_32x32x16_bf16 v[168:183], v[196:199], v[108:111], v[168:183]
  ds_read_b128 v[196:199], v1 offset:5120
  v_exp_f32 v152, v152
  v_exp_f32 v153, v153
  s_waitcnt lgkmcnt(7)
  v_mfma_f32_32x32x16_bf16 v[168:183], v[200:203], v[112:115], v[168:183]
  ds_read_b128 v[200:203], v0 offset:6144
  v_exp_f32 v154, v154
  v_exp_f32_e64 v155, v155
  v_cvt_pk_bf16_f32 v184, v152, v153
  s_waitcnt lgkmcnt(3)
  v_mfma_f32_32x32x16_bf16 v[168:183], v[204:207], v[116:119], v[168:183]
  ds_read_b128 v[204:207], v1 offset:7168
  s_barrier
  v_exp_f32 v160, v160
  s_waitcnt lgkmcnt(3)
  v_mfma_f32_32x32x16_bf16 v[168:183], v[192:195], v[120:123], v[168:183]
  ds_read_b128 v[192:195], v0 offset:8192
  v_exp_f32 v161, v161
  v_exp_f32 v162, v162
  v_cvt_pk_bf16_f32 v185, v154, v155
  s_waitcnt lgkmcnt(3)
  v_mfma_f32_32x32x16_bf16 v[168:183], v[196:199], v[124:127], v[168:183]
  ds_read_b128 v[196:199], v1 offset:9216
  v_exp_f32 v163, v163
  v_exp_f32_e64 v156, v156
  v_cvt_pk_bf16_f32 v186, v160, v161
  v_add_u32 v2, s42, v2
  s_waitcnt lgkmcnt(3)
  v_mfma_f32_32x32x16_bf16 v[168:183], v[200:203], v[128:131], v[168:183]
  ds_read_b128 v[200:203], v0 offset:10240
  v_exp_f32 v157, v157
  v_exp_f32 v158, v158
  v_cvt_pk_bf16_f32 v187, v162, v163
  v_add_u32 v3, s42, v3
  s_waitcnt lgkmcnt(3)
  v_mfma_f32_32x32x16_bf16 v[168:183], v[204:207], v[132:135], v[168:183]
  ds_read_b128 v[204:207], v1 offset:11264
  v_exp_f32 v159, v159
  v_exp_f32 v164, v164
  v_cvt_pk_bf16_f32 v188, v156, v157
  s_add_u32 s43, s43, 1
  s_cmp_eq_u32 s43, 3
  s_waitcnt lgkmcnt(3)
  v_mfma_f32_32x32x16_bf16 v[168:183], v[192:195], v[136:139], v[168:183]
  v_exp_f32 v165, v165
  v_exp_f32_e64 v166, v166
  v_cvt_pk_bf16_f32 v189, v158, v159
  s_cselect_b32 s42, s41, s40
  s_cselect_b32 s43, 0, s43
  v_add_f32 v4, v4, v152
  v_add_f32 v4, v4, v153
  s_waitcnt lgkmcnt(2)
  v_mfma_f32_32x32x16_bf16 v[168:183], v[196:199], v[140:143], v[168:183]
  v_exp_f32 v167, v167
  v_cvt_pk_bf16_f32 v190, v164, v165
  v_add_f32 v4, v4, v154
  v_add_f32 v4, v4, v155
  v_add_f32 v4, v4, v160
  s_waitcnt lgkmcnt(1)
  v_mfma_f32_32x32x16_bf16 v[168:183], v[200:203], v[144:147], v[168:183]
  v_cvt_pk_bf16_f32 v191, v166, v167
  v_add_f32 v4, v4, v161
  v_add_f32 v4, v4, v162
  v_add_f32 v4, v4, v163
  v_add_f32 v4, v4, v156
  s_waitcnt lgkmcnt(0)
  v_mfma_f32_32x32x16_bf16 v[168:183], v[204:207], v[148:151], v[168:183]
  v_add_f32 v4, v4, v157
  v_add_f32 v4, v4, v158
  v_add_f32 v4, v4, v159
  s_add_u32 s48, s48, 1
  s_branch k2_loopB
k2_loop:
  s_waitcnt lgkmcnt(11)
  v_mfma_f32_32x32x16_bf16 v[168:183], v[192:195], v[104:107], 0
  ds_read_b128 v[192:195], v0 offset:4096
  v_exp_f32 v156, v156
  v_cvt_pk_bf16_f32 v184, v152, v153
  s_waitcnt lgkmcnt(9)
  v_mfma_f32_32x32x16_bf16 v[168:183], v[196:199], v[108:111], v[168:183]
  ds_read_b128 v[196:199], v1 offset:5120
  v_exp_f32 v157, v157
  v_cvt_pk_bf16_f32 v185, v154, v155
  s_waitcnt lgkmcnt(7)
  v_mfma_f32_32x32x16_bf16 v[168:183], v[200:203], v[112:115], v[168:183]
  ds_read_b128 v[200:203], v0 offset:6144
  v_exp_f32 v158, v158
  v_cvt_pk_bf16_f32 v186, v160, v161
  s_waitcnt lgkmcnt(3)
  v_mfma_f32_32x32x16_bf16 v[168:183], v[204:207], v[116:119], v[168:183]
  ds_read_b128 v[204:207], v1 offset:7168
  s_barrier
  s_waitcnt lgkmcnt(3)
  v_mfma_f32_32x32x16_bf16 v[168:183], v[192:195], v[120:123], v[168:183]
  ds_read_b128 v[192:195], v0 offset:8192
  v_exp_f32 v159, v159
  v_cvt_pk_bf16_f32 v187, v162, v163
  s_waitcnt lgkmcnt(3)
  v_mfma_f32_32x32x16_bf16 v[168:183], v[196:199], v[124:127], v[168:183]
  ds_read_b128 v[196:199], v1 offset:9216
  v_exp_f32 v164, v164
  v_add_u32 v2, s42, v2
  s_waitcnt lgkmcnt(3)
  v_mfma_f32_32x32x16_bf16 v[168:183], v[200:203], v[128:131], v[168:183]
  ds_read_b128 v[200:203], v0 offset:10240
.Lk2_pad3:
  s_cbranch_execz .Lk2_pad6
  v_exp_f32 v165, v165
  v_add_u32 v3, s42, v3
  s_waitcnt lgkmcnt(3)
  v_mfma_f32_32x32x16_bf16 v[168:183], v[204:207], v[132:135], v[168:183]
  ds_read_b128 v[204:207], v1 offset:11264
  v_exp_f32 v166, v166
  v_add_f32 v4, v4, v152
  s_add_u32 s43, s43, 1
  s_cmp_eq_u32 s43, 3
  s_waitcnt lgkmcnt(3)
  v_mfma_f32_32x32x16_bf16 v[168:183], v[192:195], v[136:139], v[168:183]
  v_exp_f32 v167, v167
  v_cvt_pk_bf16_f32 v188, v156, v157
  v_cvt_pk_bf16_f32 v189, v158, v159
  v_add_f32 v4, v4, v153
  s_cselect_b32 s42, s41, s40
  s_cselect_b32 s43, 0, s43
  s_waitcnt lgkmcnt(2)
  v_mfma_f32_32x32x16_bf16 v[168:183], v[196:199], v[140:143], v[168:183]
  v_cvt_pk_bf16_f32 v190, v164, v165
  v_cvt_pk_bf16_f32 v191, v166, v167
  v_add_f32 v4, v4, v154
  v_add_f32 v4, v4, v155
  v_add_f32 v4, v4, v160
  s_waitcnt lgkmcnt(1)
  v_mfma_f32_32x32x16_bf16 v[168:183], v[200:203], v[144:147], v[168:183]
  v_add_f32 v4, v4, v161
  v_add_f32 v4, v4, v162
  v_add_f32 v4, v4, v163
  v_add_f32 v4, v4, v156
  s_waitcnt lgkmcnt(0)
  v_mfma_f32_32x32x16_bf16 v[168:183], v[204:207], v[148:151], v[168:183]
  v_add_f32 v4, v4, v157
  v_add_f32 v4, v4, v158
  v_add_f32 v4, v4, v159
  s_add_u32 s48, s48, 1
k2_loopB:
  v_mfma_f32_32x32x16_bf16 v[8:23], v[208:211], v[184:187], v[8:23]
  ds_read_b64_tr_b16 v[208:209], v2 offset:0
  ds_read_b64_tr_b16 v[210:211], v2 offset:256
  v_add_f32 v4, v4, v164
  v_add_f32_e64 v4, v4, v165
  v_mfma_f32_32x32x16_bf16 v[8:23], v[212:215], v[188:191], v[8:23]
  ds_read_b64_tr_b16 v[212:213], v3 offset:0
  ds_read_b64_tr_b16 v[214:215], v3 offset:256
  v_add_f32 v4, v4, v166
  v_add_f32 v4, v4, v167
  v_mfma_f32_32x32x16_bf16 v[24:39], v[216:219], v[184:187], v[24:39]
  ds_read_b64_tr_b16 v[216:217], v2 offset:2048
  ds_read_b64_tr_b16 v[218:219], v2 offset:2304
  v_exp_f32_e64 v168, v168
  v_mfma_f32_32x32x16_bf16 v[24:39], v[220:223], v[188:191], v[24:39]
  ds_read_b64_tr_b16 v[220:221], v3 offset:2048
  ds_read_b64_tr_b16 v[222:223], v3 offset:2304
  v_exp_f32_e64 v169, v169
  v_mfma_f32_32x32x16_bf16 v[40:55], v[224:227], v[184:187], v[40:55]
  ds_read_b64_tr_b16 v[224:225], v2 offset:4096
  ds_read_b64_tr_b16 v[226:227], v2 offset:4352
  v_exp_f32_e64 v170, v170
  ds_read_b32 v7, v5 offset:384
  v_mfma_f32_32x32x16_bf16 v[40:55], v[228:231], v[188:191], v[40:55]
  ds_read_b64_tr_b16 v[228:229], v3 offset:4096
  ds_read_b64_tr_b16 v[230:231], v3 offset:4352
  v_exp_f32 v171, v171
  v_add_u32 v0, s42, v0
  v_mfma_f32_32x32x16_bf16 v[56:71], v[232:235], v[184:187], v[56:71]
  ds_read_b64_tr_b16 v[232:233], v2 offset:6144
  ds_read_b64_tr_b16 v[234:235], v2 offset:6400
  v_exp_f32 v176, v176
  v_add_u32 v1, s42, v1
  v_mfma_f32_32x32x16_bf16 v[56:71], v[236:239], v[188:191], v[56:71]
  ds_read_b64_tr_b16 v[236:237], v3 offset:6144
  ds_read_b64_tr_b16 v[238:239], v3 offset:6400
  s_waitcnt lgkmcnt(6)
  v_cmp_gt_u32 vcc, s48, v7
  s_nop 0
  s_cbranch_vccnz k2_poll1
k2_back1:
  v_mfma_f32_32x32x16_bf16 v[72:87], v[240:243], v[184:187], v[72:87]
  ds_read_b128 v[192:195], v0 offset:0
  ds_read_b64_tr_b16 v[240:241], v2 offset:8192
  ds_read_b64_tr_b16 v[242:243], v2 offset:8448
  v_exp_f32_e64 v177, v177
  v_mfma_f32_32x32x16_bf16 v[72:87], v[244:247], v[188:191], v[72:87]
  ds_read_b128 v[196:199], v1 offset:1024
  ds_read_b64_tr_b16 v[244:245], v3 offset:8192
  ds_read_b64_tr_b16 v[246:247], v3 offset:8448
  v_exp_f32_e64 v178, v178
  v_mfma_f32_32x32x16_bf16 v[88:103], v[248:251], v[184:187], v[88:103]
  ds_read_b128 v[200:203], v0 offset:2048
  ds_read_b64_tr_b16 v[248:249], v2 offset:10240
  ds_read_b64_tr_b16 v[250:251], v2 offset:10496
  v_exp_f32_e64 v179, v179
  v_mfma_f32_32x32x16_bf16 v[88:103], v[252:255], v[188:191], v[88:103]
  ds_read_b64_tr_b16 v[252:253], v3 offset:10240
  ds_read_b64_tr_b16 v[254:255], v3 offset:10496
  ds_read_b128 v[204:207], v1 offset:3072
  s_cmp_eq_u32 s48, 9
  s_cbranch_scc1 k2_last
  s_waitcnt lgkmcnt(11)
  v_mfma_f32_32x32x16_bf16 v[152:167], v[192:195], v[104:107], 0
  ds_read_b128 v[192:195], v0 offset:4096
  v_exp_f32 v172, v172
  v_cvt_pk_bf16_f32 v184, v168, v169
  s_waitcnt lgkmcnt(9)
  v_mfma_f32_32x32x16_bf16 v[152:167], v[196:199], v[108:111], v[152:167]
  ds_read_b128 v[196:199], v1 offset:5120
  v_exp_f32 v173, v173
  v_cvt_pk_bf16_f32 v185, v170, v171
  s_waitcnt lgkmcnt(7)
  v_mfma_f32_32x32x16_bf16 v[152:167], v[200:203], v[112:115], v[152:167]
  ds_read_b128 v[200:203], v0 offset:6144
  v_exp_f32 v174, v174
  v_cvt_pk_bf16_f32 v186, v176, v177
  s_waitcnt lgkmcnt(3)
  v_mfma_f32_32x32x16_bf16 v[152:167], v[204:207], v[116:119], v[152:167]
  ds_read_b128 v[204:207], v1 offset:7168
  s_barrier
  s_waitcnt lgkmcnt(3)
  v_mfma_f32_32x32x16_bf16 v[152:167], v[192:195], v[120:123], v[152:167]
  ds_read_b128 v[192:195], v0 offset:8192
  v_exp_f32 v175, v175
  v_cvt_pk_bf16_f32 v187, v178, v179
  s_waitcnt lgkmcnt(3)
  v_mfma_f32_32x32x16_bf16 v[152:167], v[196:199], v[124:127], v[152:167]
  ds_read_b128 v[196:199], v1 offset:9216
  v_exp_f32 v180, v180
  v_add_u32 v2, s42, v2
  s_waitcnt lgkmcnt(3)
  v_mfma_f32_32x32x16_bf16 v[152:167], v[200:203], v[128:131], v[152:167]
  ds_read_b128 v[200:203], v0 offset:10240
  v_exp_f32 v181, v181
  v_add_u32 v3, s42, v3
  s_waitcnt lgkmcnt(3)
  v_mfma_f32_32x32x16_bf16 v[152:167], v[204:207], v[132:135], v[152:167]
  ds_read_b128 v[204:207], v1 offset:11264
  v_exp_f32 v182, v182
  v_add_f32 v4, v4, v168
  s_add_u32 s43, s43, 1
  s_cmp_eq_u32 s43, 3
  s_waitcnt lgkmcnt(3)
  v_mfma_f32_32x32x16_bf16 v[152:167], v[192:195], v[136:139], v[152:167]
  v_exp_f32_e64 v183, v183
  v_cvt_pk_bf16_f32 v188, v172, v173
  v_cvt_pk_bf16_f32 v189, v174, v175
  v_add_f32 v4, v4, v169
  s_cselect_b32 s42, s41, s40
  s_cselect_b32 s43, 0, s43
  s_waitcnt lgkmcnt(2)
  v_mfma_f32_32x32x16_bf16 v[152:167], v[196:199], v[140:143], v[152:167]
  v_cvt_pk_bf16_f32 v190, v180, v181
  v_cvt_pk_bf16_f32 v191, v182, v183
  v_add_f32 v4, v4, v170
  v_add_f32 v4, v4, v171
  v_add_f32 v4, v4, v176
  s_waitcnt lgkmcnt(1)
  v_mfma_f32_32x32x16_bf16 v[152:167], v[200:203], v[144:147], v[152:167]
  v_add_f32 v4, v4, v177
  v_add_f32 v4, v4, v178
  v_add_f32 v4, v4, v179
  v_add_f32 v4, v4, v172
  s_waitcnt lgkmcnt(0)
  v_mfma_f32_32x32x16_bf16 v[152:167], v[204:207], v[148:151], v[152:167]
  v_add_f32 v4, v4, v173
  v_add_f32 v4, v4, v174
  v_add_f32 v4, v4, v175
  s_add_u32 s48, s48, 1
  v_mfma_f32_32x32x16_bf16 v[8:23], v[208:211], v[184:187], v[8:23]
  ds_read_b64_tr_b16 v[208:209], v2 offset:0
.Lk2_pad4:
  s_cbranch_execz .Lk2_pad7
  ds_read_b64_tr_b16 v[210:211], v2 offset:256
  v_add_f32 v4, v4, v180
  v_add_f32 v4, v4, v181
  v_mfma_f32_32x32x16_bf16 v[8:23], v[212:215], v[188:191], v[8:23]
  ds_read_b64_tr_b16 v[212:213], v3 offset:0
  ds_read_b64_tr_b16 v[214:215], v3 offset:256
  v_add_f32 v4, v4, v182
  v_add_f32 v4, v4, v183
  v_mfma_f32_32x32x16_bf16 v[24:39], v[216:219], v[184:187], v[24:39]
  ds_read_b64_tr_b16 v[216:217], v2 offset:2048
  ds_read_b64_tr_b16 v[218:219], v2 offset:2304
  v_exp_f32_e64 v152, v152
  v_mfma_f32_32x32x16_bf16 v[24:39], v[220:223], v[188:191], v[24:39]
  ds_read_b64_tr_b16 v[220:221], v3 offset:2048
  ds_read_b64_tr_b16 v[222:223], v3 offset:2304
  v_exp_f32_e64 v153, v153
  v_mfma_f32_32x32x16_bf16 v[40:55], v[224:227], v[184:187], v[40:55]
  ds_read_b64_tr_b16 v[224:225], v2 offset:4096
  ds_read_b64_tr_b16 v[226:227], v2 offset:4352
  v_exp_f32_e64 v154, v154
  ds_read_b32 v7, v5 offset:384
  v_mfma_f32_32x32x16_bf16 v[40:55], v[228:231], v[188:191], v[40:55]
  ds_read_b64_tr_b16 v[228:229], v3 offset:4096
  ds_read_b64_tr_b16 v[230:231], v3 offset:4352
  v_exp_f32 v155, v155
  v_add_u32 v0, s42, v0
  v_mfma_f32_32x32x16_bf16 v[56:71], v[232:235], v[184:187], v[56:71]
  ds_read_b64_tr_b16 v[232:233], v2 offset:6144
  ds_read_b64_tr_b16 v[234:235], v2 offset:6400
  v_exp_f32 v160, v160
  v_add_u32 v1, s42, v1
  v_mfma_f32_32x32x16_bf16 v[56:71], v[236:239], v[188:191], v[56:71]
  ds_read_b64_tr_b16 v[236:237], v3 offset:6144
  ds_read_b64_tr_b16 v[238:239], v3 offset:6400
  s_waitcnt lgkmcnt(6)
  v_cmp_gt_u32 vcc, s48, v7
  s_nop 0
  s_cbranch_vccnz k2_poll2
k2_back2:
  v_mfma_f32_32x32x16_bf16 v[72:87], v[240:243], v[184:187], v[72:87]
  ds_read_b128 v[192:195], v0 offset:0
  ds_read_b64_tr_b16 v[240:241], v2 offset:8192
  ds_read_b64_tr_b16 v[242:243], v2 offset:8448
  v_exp_f32_e64 v161, v161
  v_mfma_f32_32x32x16_bf16 v[72:87], v[244:247], v[188:191], v[72:87]
  ds_read_b128 v[196:199], v1 offset:1024
  ds_read_b64_tr_b16 v[244:245], v3 offset:8192
  ds_read_b64_tr_b16 v[246:247], v3 offset:8448
  v_exp_f32_e64 v162, v162
  v_mfma_f32_32x32x16_bf16 v[88:103], v[248:251], v[184:187], v[88:103]
  ds_read_b128 v[200:203], v0 offset:2048
  ds_read_b64_tr_b16 v[248:249], v2 offset:10240
  ds_read_b64_tr_b16 v[250:251], v2 offset:10496
  v_exp_f32_e64 v163, v163
  v_mfma_f32_32x32x16_bf16 v[88:103], v[252:255], v[188:191], v[88:103]
  ds_read_b64_tr_b16 v[252:253], v3 offset:10240
  ds_read_b64_tr_b16 v[254:255], v3 offset:10496
  ds_read_b128 v[204:207], v1 offset:3072
  s_branch k2_loop
k2_last:
  v_cvt_pk_bf16_f32 v184, v168, v169
  v_cvt_pk_bf16_f32 v185, v170, v171
  v_cvt_pk_bf16_f32 v186, v176, v177
  v_cvt_pk_bf16_f32 v187, v178, v179
  s_nop 1
  v_mfma_f32_32x32x16_bf16 v[8:23], v[208:211], v[184:187], v[8:23]
  v_exp_f32 v172, v172
  v_exp_f32 v173, v173
  v_add_u32_e64 v140, s52, v6
  v_mfma_f32_32x32x16_bf16 v[24:39], v[216:219], v[184:187], v[24:39]
  v_exp_f32 v174, v174
  v_exp_f32 v175, v175
  v_cvt_pk_bf16_f32 v188, v172, v173
  v_mfma_f32_32x32x16_bf16 v[40:55], v[224:227], v[184:187], v[40:55]
  v_exp_f32 v180, v180
  v_exp_f32 v181, v181
  v_cvt_pk_bf16_f32 v189, v174, v175
  s_waitcnt lgkmcnt(14)
  v_mfma_f32_32x32x16_bf16 v[56:71], v[232:235], v[184:187], v[56:71]
  v_exp_f32 v182, v182
  v_exp_f32_e64 v183, v183
  v_cvt_pk_bf16_f32 v190, v180, v181
  v_cvt_pk_bf16_f32 v191, v182, v183
  s_nop 1
  v_mfma_f32_32x32x16_bf16 v[8:23], v[212:215], v[188:191], v[8:23]
  v_add_f32 v4, v4, v168
  v_add_f32 v4, v4, v169
  v_add_f32 v4, v4, v170
  v_add_f32 v4, v4, v171
  v_add_f32 v4, v4, v176
  v_add_f32_e64 v4, v4, v177
  v_mfma_f32_32x32x16_bf16 v[24:39], v[220:223], v[188:191], v[24:39]
  v_add_f32 v4, v4, v178
  v_add_f32 v4, v4, v179
  v_add_f32 v4, v4, v172
  v_add_f32 v4, v4, v173
  v_add_f32 v4, v4, v174
  v_add_f32 v4, v4, v175
  v_mfma_f32_32x32x16_bf16 v[40:55], v[228:231], v[188:191], v[40:55]
  v_add_f32 v4, v4, v180
  v_add_f32 v4, v4, v181
  v_add_f32 v4, v4, v182
  v_add_f32 v4, v4, v183
  v_bfe_u32 v147, v6, 3, 5
  v_lshrrev_b32 v148, 8, v6
  v_lshlrev_b32 v146, 5, v147
  v_lshl_add_u32 v145, v148, 2, v146
  v_add_u32_e64 v145, s58, v145
  ds_write_b32 v145, v4
  s_waitcnt lgkmcnt(13)
  s_nop 0
  v_mfma_f32_32x32x16_bf16 v[56:71], v[236:239], v[188:191], v[56:71]
  v_cvt_pk_bf16_f32 v12, v12, v13
  v_cvt_pk_bf16_f32 v13, v14, v15
  v_cvt_pk_bf16_f32 v16, v16, v17
  v_cvt_pk_bf16_f32 v17, v18, v19
  v_cvt_pk_bf16_f32 v20, v20, v21
  v_cvt_pk_bf16_f32 v21, v22, v23
  ds_write_b64 v140, v[12:13] offset:0
  ds_write_b64 v140, v[16:17] offset:3072
  ds_write_b64 v140, v[20:21] offset:6144
  s_waitcnt lgkmcnt(13)
  s_nop 0
  v_mfma_f32_32x32x16_bf16 v[72:87], v[240:243], v[184:187], v[72:87]
  v_cvt_pk_bf16_f32 v28, v28, v29
  v_cvt_pk_bf16_f32 v29, v30, v31
  v_cvt_pk_bf16_f32 v32, v32, v33
  v_cvt_pk_bf16_f32 v33, v34, v35
  v_cvt_pk_bf16_f32 v36, v36, v37
  v_cvt_pk_bf16_f32 v37, v38, v39
  ds_write_b64 v140, v[28:29] offset:512
  ds_write_b64 v140, v[32:33] offset:3584
  ds_write_b64 v140, v[36:37] offset:6656
  s_waitcnt lgkmcnt(13)
  s_nop 0
  v_mfma_f32_32x32x16_bf16 v[72:87], v[244:247], v[188:191], v[72:87]
  v_cvt_pk_bf16_f32 v44, v44, v45
  v_cvt_pk_bf16_f32 v45, v46, v47
  v_cvt_pk_bf16_f32 v48, v48, v49
  v_cvt_pk_bf16_f32 v49, v50, v51
  v_cvt_pk_bf16_f32 v52, v52, v53
  v_cvt_pk_bf16_f32 v53, v54, v55
  ds_write_b64 v140, v[44:45] offset:1024
  ds_write_b64 v140, v[48:49] offset:4096
  ds_write_b64 v140, v[52:53] offset:7168
  s_waitcnt lgkmcnt(13)
  s_nop 0
  v_mfma_f32_32x32x16_bf16 v[88:103], v[248:251], v[184:187], v[88:103]
  v_cvt_pk_bf16_f32 v60, v60, v61
  v_cvt_pk_bf16_f32 v61, v62, v63
  v_cvt_pk_bf16_f32 v64, v64, v65
  v_cvt_pk_bf16_f32 v65, v66, v67
  v_cvt_pk_bf16_f32 v68, v68, v69
.Lk2_pad5:
  s_cbranch_execz .Lk2_pad8
  v_cvt_pk_bf16_f32 v69, v70, v71
  ds_write_b64 v140, v[60:61] offset:1536
  ds_write_b64 v140, v[64:65] offset:4608
  ds_write_b64 v140, v[68:69] offset:7680
  s_waitcnt lgkmcnt(14)
  v_mfma_f32_32x32x16_bf16 v[88:103], v[252:255], v[188:191], v[88:103]
  v_add_u32 v141, s53, v6
  v_add_u32 v142, s54, v6
  v_add_u32 v143, s55, v6
  v_add_u32 v146, s59, v146
  v_xor_b32 v144, s57, v147
  v_lshlrev_b32 v144, 4, v144
  v_lshl_add_u32 v144, v148, 3, v144
  v_add_u32_e64 v144, s56, v144
  v_cvt_pk_bf16_f32 v76, v76, v77
  v_cvt_pk_bf16_f32 v77, v78, v79
  v_cvt_pk_bf16_f32 v80, v80, v81
  v_cvt_pk_bf16_f32 v81, v82, v83
  v_cvt_pk_bf16_f32 v84, v84, v85
  v_cvt_pk_bf16_f32 v85, v86, v87
  ds_write_b64 v140, v[76:77] offset:2048
  ds_write_b64 v140, v[80:81] offset:5120
  ds_write_b64 v140, v[84:85] offset:8192
  v_cvt_pk_bf16_f32 v92, v92, v93
  v_cvt_pk_bf16_f32 v93, v94, v95
  v_cvt_pk_bf16_f32 v96, v96, v97
  v_cvt_pk_bf16_f32 v97, v98, v99
  v_cvt_pk_bf16_f32 v100, v100, v101
  v_cvt_pk_bf16_f32 v101, v102, v103
  ds_write_b64 v140, v[92:93] offset:2560
  ds_write_b64 v140, v[96:97] offset:5632
  ds_write_b64 v140, v[100:101] offset:8704
k2_tail:
  s_waitcnt lgkmcnt(0)
  s_barrier
  ds_read_b64 v[104:105], v141 offset:0
  ds_read_b64 v[106:107], v142 offset:3072
  ds_read_b64 v[108:109], v143 offset:6144
  ds_read_b64 v[110:111], v141 offset:512
  ds_read_b64 v[112:113], v142 offset:3584
  ds_read_b64 v[114:115], v143 offset:6656
  ds_read_b64 v[116:117], v141 offset:1024
  ds_read_b64 v[118:119], v142 offset:4096
  ds_read_b64 v[120:121], v143 offset:7168
  ds_read_b64 v[122:123], v141 offset:1536
  ds_read_b64 v[124:125], v142 offset:4608
  ds_read_b64 v[126:127], v143 offset:7680
  ds_read_b64 v[128:129], v141 offset:2048
  ds_read_b64 v[130:131], v142 offset:5120
  ds_read_b64 v[132:133], v143 offset:8192
  ds_read_b64 v[134:135], v141 offset:2560
  ds_read_b64 v[136:137], v142 offset:5632
  ds_read_b64 v[138:139], v143 offset:8704
  ds_read_b128 v[192:195], v146
  ds_read_b128 v[196:199], v146 offset:16
  s_mov_b32 s14, 0x00003f80
  s_mov_b32 s15, 0x3f800000
  s_waitcnt lgkmcnt(15)
  v_dot2c_f32_bf16 v8, s14, v104
  v_dot2c_f32_bf16 v9, s15, v104
  v_dot2c_f32_bf16 v10, s14, v105
  v_dot2c_f32_bf16 v11, s15, v105
  v_dot2c_f32_bf16 v8, s14, v106
  v_dot2c_f32_bf16 v9, s15, v106
  v_dot2c_f32_bf16 v10, s14, v107
  v_dot2c_f32_bf16 v11, s15, v107
  v_dot2c_f32_bf16 v8, s14, v108
  v_dot2c_f32_bf16 v9, s15, v108
  v_dot2c_f32_bf16 v10, s14, v109
  v_dot2c_f32_bf16 v11, s15, v109
  s_nop 0
  v_cvt_pk_bf16_f32 v8, v8, v9
  s_nop 0
  v_cvt_pk_bf16_f32 v9, v10, v11
  ds_write_b64 v144, v[8:9] offset:0
  v_dot2c_f32_bf16 v24, s14, v110
  v_dot2c_f32_bf16 v25, s15, v110
  v_dot2c_f32_bf16 v26, s14, v111
  v_dot2c_f32_bf16 v27, s15, v111
  v_dot2c_f32_bf16 v24, s14, v112
  v_dot2c_f32_bf16 v25, s15, v112
  v_dot2c_f32_bf16 v26, s14, v113
  v_dot2c_f32_bf16 v27, s15, v113
  s_waitcnt lgkmcnt(15)
  v_dot2c_f32_bf16 v24, s14, v114
  v_dot2c_f32_bf16 v25, s15, v114
  v_dot2c_f32_bf16 v26, s14, v115
  v_dot2c_f32_bf16 v27, s15, v115
  s_nop 0
  v_cvt_pk_bf16_f32 v24, v24, v25
  s_nop 0
  v_cvt_pk_bf16_f32 v25, v26, v27
  ds_write_b64 v144, v[24:25] offset:2048
  s_waitcnt lgkmcnt(15)
  v_dot2c_f32_bf16 v40, s14, v116
  v_dot2c_f32_bf16 v41, s15, v116
  v_dot2c_f32_bf16 v42, s14, v117
  v_dot2c_f32_bf16 v43, s15, v117
  s_waitcnt lgkmcnt(14)
  v_dot2c_f32_bf16 v40, s14, v118
  v_dot2c_f32_bf16 v41, s15, v118
  v_dot2c_f32_bf16 v42, s14, v119
  v_dot2c_f32_bf16 v43, s15, v119
  s_waitcnt lgkmcnt(13)
  v_dot2c_f32_bf16 v40, s14, v120
  v_dot2c_f32_bf16 v41, s15, v120
  v_dot2c_f32_bf16 v42, s14, v121
  v_dot2c_f32_bf16 v43, s15, v121
  s_nop 0
  v_cvt_pk_bf16_f32 v40, v40, v41
  s_nop 0
  v_cvt_pk_bf16_f32 v41, v42, v43
  ds_write_b64 v144, v[40:41] offset:4096
  s_waitcnt lgkmcnt(13)
  v_dot2c_f32_bf16 v56, s14, v122
  v_dot2c_f32_bf16 v57, s15, v122
  v_dot2c_f32_bf16 v58, s14, v123
  v_dot2c_f32_bf16 v59, s15, v123
  s_waitcnt lgkmcnt(12)
  v_dot2c_f32_bf16 v56, s14, v124
  v_dot2c_f32_bf16 v57, s15, v124
  v_dot2c_f32_bf16 v58, s14, v125
  v_dot2c_f32_bf16 v59, s15, v125
  s_waitcnt lgkmcnt(11)
  v_dot2c_f32_bf16 v56, s14, v126
  v_dot2c_f32_bf16 v57, s15, v126
  v_dot2c_f32_bf16 v58, s14, v127
  v_dot2c_f32_bf16 v59, s15, v127
  s_nop 0
  v_cvt_pk_bf16_f32 v56, v56, v57
  s_nop 0
  v_cvt_pk_bf16_f32 v57, v58, v59
  ds_write_b64 v144, v[56:57] offset:6144
  s_waitcnt lgkmcnt(11)
  v_dot2c_f32_bf16 v72, s14, v128
  v_dot2c_f32_bf16 v73, s15, v128
  v_dot2c_f32_bf16 v74, s14, v129
  v_dot2c_f32_bf16 v75, s15, v129
  s_waitcnt lgkmcnt(10)
  v_dot2c_f32_bf16 v72, s14, v130
  v_dot2c_f32_bf16 v73, s15, v130
  v_dot2c_f32_bf16 v74, s14, v131
  v_dot2c_f32_bf16 v75, s15, v131
  s_waitcnt lgkmcnt(9)
  v_dot2c_f32_bf16 v72, s14, v132
  v_dot2c_f32_bf16 v73, s15, v132
  v_dot2c_f32_bf16 v74, s14, v133
  v_dot2c_f32_bf16 v75, s15, v133
  s_nop 0
  v_cvt_pk_bf16_f32 v72, v72, v73
  s_nop 0
  v_cvt_pk_bf16_f32 v73, v74, v75
  ds_write_b64 v144, v[72:73] offset:8192
  s_waitcnt lgkmcnt(9)
  v_dot2c_f32_bf16 v88, s14, v134
  v_dot2c_f32_bf16 v89, s15, v134
  v_dot2c_f32_bf16 v90, s14, v135
  v_dot2c_f32_bf16 v91, s15, v135
  s_waitcnt lgkmcnt(8)
  v_dot2c_f32_bf16 v88, s14, v136
  v_dot2c_f32_bf16 v89, s15, v136
  v_dot2c_f32_bf16 v90, s14, v137
  v_dot2c_f32_bf16 v91, s15, v137
  s_waitcnt lgkmcnt(7)
  v_dot2c_f32_bf16 v88, s14, v138
  v_dot2c_f32_bf16 v89, s15, v138
  v_dot2c_f32_bf16 v90, s14, v139
  v_dot2c_f32_bf16 v91, s15, v139
  s_nop 0
  v_cvt_pk_bf16_f32 v88, v88, v89
  s_nop 0
  v_cvt_pk_bf16_f32 v89, v90, v91
  ds_write_b64 v144, v[88:89] offset:10240
  s_waitcnt lgkmcnt(7)
  v_add_f32 v192, v192, v193
  v_add_f32 v194, v194, v195
  s_waitcnt lgkmcnt(6)
  v_add_f32 v196, v196, v197
  v_add_f32 v198, v198, v199
  v_add_f32 v192, v192, v194
  v_add_f32 v196, v196, v198
  v_add_f32 v192, v192, v196
  s_mov_b32 s8, 0x5d800000
  s_mov_b32 s9, 0x21800000
  s_mov_b64 s[12:13], 0
  v_cmp_nge_f32 vcc, s8, v192
  v_cmp_nle_f32 s[10:11], s9, v192
  s_or_b64 s[12:13], s[12:13], vcc
  s_or_b64 s[12:13], s[12:13], s[10:11]
.Lk2_pad6:
  s_cbranch_execz .Lk2_pad9
  s_cmp_lg_u64 s[12:13], 0
  s_cselect_b32 s8, 1, 0
  s_cmp_eq_u32 s44, 0
  s_cselect_b32 s45, s8, 0
  s_waitcnt lgkmcnt(0)
  s_barrier
  s_cmp_lg_u32 s45, 0
  s_cbranch_scc1 k2_crestart
  s_endpgm
k2_crestart:
  s_mov_b32 s44, 1
  s_branch k2_cstart
k2_poll0:
  s_sub_u32 s49, s49, 1
  s_cbranch_scc1 k2_exit
  ds_read_b32 v7, v5 offset:384
  s_waitcnt lgkmcnt(0)
  v_cmp_gt_u32 vcc, s48, v7
  s_nop 0
  s_cbranch_vccnz k2_poll0
  s_branch k2_back0
k2_poll1:
  s_sub_u32 s49, s49, 1
  s_cbranch_scc1 k2_exit
  ds_read_b32 v7, v5 offset:384
  s_waitcnt lgkmcnt(0)
  v_cmp_gt_u32 vcc, s48, v7
  s_nop 0
  s_cbranch_vccnz k2_poll1
  s_branch k2_back1
k2_poll2:
  s_sub_u32 s49, s49, 1
  s_cbranch_scc1 k2_exit
  ds_read_b32 v7, v5 offset:384
  s_waitcnt lgkmcnt(0)
  v_cmp_gt_u32 vcc, s48, v7
  s_nop 0
  s_cbranch_vccnz k2_poll2
  s_branch k2_back2
k2_loader2:
  v_and_b32 v11, 15, v1
  v_add_u32 v10, 4, v11
  v_cmp_gt_u32 vcc, 4, v11
  s_nop 1
  v_cndmask_b32 v10, v10, v11, vcc
  v_subrev_u32 v15, 8, v11
  v_cmp_lt_u32 vcc, 11, v11
  s_nop 1
  v_cndmask_b32 v10, v10, v15, vcc
  s_mul_i32 s9, s7, 6
  v_lshrrev_b32 v11, 5, v1
  v_add_u32 v11, s9, v11
  v_add_u32 v15, 0, v11
  v_and_b32 v12, 3, v15
  v_lshlrev_b32 v12, 2, v12
  v_xor_b32 v12, v12, v10
  v_lshlrev_b32 v12, 4, v12
  v_lshl_add_u32 v12, v15, 9, v12
  v_bfe_u32 v15, v1, 4, 1
  v_lshl_add_u32 v12, v15, 3, v12
  v_add_u32 v15, 2, v11
  v_and_b32 v13, 3, v15
  v_lshlrev_b32 v13, 2, v13
  v_xor_b32 v13, v13, v10
  v_lshlrev_b32_e64 v13, 4, v13
  v_lshl_add_u32 v13, v15, 9, v13
  v_bfe_u32 v15, v1, 4, 1
  v_lshl_add_u32 v13, v15, 3, v13
  v_add_u32 v15, 4, v11
  v_and_b32 v14, 3, v15
  v_lshlrev_b32 v14, 2, v14
  v_xor_b32 v14, v14, v10
  v_lshlrev_b32_e64 v14, 4, v14
  v_lshl_add_u32 v14, v15, 9, v14
  v_bfe_u32 v15, v1, 4, 1
  v_lshl_add_u32 v14, v15, 3, v14
  v_lshrrev_b32 v11, 4, v1
  v_lshlrev_b32 v16, 2, v11
  v_xor_b32 v16, v16, v10
  v_lshlrev_b32 v16, 4, v16
  v_lshl_add_u32 v16, v11, 9, v16
  v_add_u32 v16, 147456, v16
  v_bfe_u32 v11, v1, 4, 1
  v_lshl_add_u32 v17, v11, 4, v10
  v_mul_u32_u24 v17, 384, v17
  v_lshrrev_b32_e64 v11, 5, v1
  v_lshl_add_u32 v17, v11, 4, v17
  v_lshlrev_b32_e64 v18, 5, v10
  v_add_u32 v18, 159744, v18
  v_bfe_u32 v11, v1, 4, 1
  v_lshl_add_u32 v56, v11, 4, v10
  v_mul_u32_u24 v56, 400, v56
  v_lshrrev_b32_e64 v11, 5, v1
  v_lshl_add_u32 v56, v11, 4, v56
  s_mul_i32 s9, s7, 96
  v_add_u32_e64 v56, s9, v56
  s_mul_i32 s9, s7, 192
  v_add_u32_e64 v11, s9, v1
  v_mul_u32_u24 v15, 2731, v11
  v_lshrrev_b32 v15, 16, v15
  v_lshlrev_b32 v11, 4, v11
  v_lshl_add_u32 v57, v15, 4, v11
  v_add_u32 v11, s9, v1
  v_add_u32 v11, 64, v11
  v_mul_u32_u24 v15, 2731, v11
  v_lshrrev_b32 v15, 16, v15
  v_lshlrev_b32 v11, 4, v11
  v_lshl_add_u32 v58, v15, 4, v11
  v_add_u32_e64 v11, s9, v1
  v_add_u32 v11, 128, v11
  v_mul_u32_u24 v15, 2731, v11
  v_lshrrev_b32 v15, 16, v15
  v_lshlrev_b32 v11, 4, v11
  v_lshl_add_u32 v59, v15, 4, v11
  v_lshlrev_b32 v17, 4, v1
  v_lshlrev_b32 v19, 3, v10
  s_barrier
  s_and_b32 s11, s11, 31
  s_mul_i32 s13, s11, 12288
  s_add_u32 s13, s13, s10
  s_add_u32 s11, s11, 4
  s_add_u32 m0, s12, 0
  s_nop 0
  buffer_load_dwordx4 v2, s[32:35], s13 offen offset:0 lds
  buffer_load_dwordx4 v2, s[32:35], s13 offen offset:1024 lds
  buffer_load_dwordx4 v2, s[32:35], s13 offen offset:2048 lds
  buffer_load_dwordx4 v2, s[32:35], s13 offen offset:3072 lds
  s_add_u32 s13, s13, 4096
  s_add_u32 m0, s12, 4096
  s_nop 0
  buffer_load_dwordx4 v2, s[32:35], s13 offen offset:0 lds
  buffer_load_dwordx4 v2, s[32:35], s13 offen offset:1024 lds
  buffer_load_dwordx4 v2, s[32:35], s13 offen offset:2048 lds
  buffer_load_dwordx4 v2, s[32:35], s13 offen offset:3072 lds
  s_add_u32 s13, s13, 4096
  s_add_u32 m0, s12, 8192
  s_nop 0
  buffer_load_dwordx4 v2, s[32:35], s13 offen offset:0 lds
  buffer_load_dwordx4 v2, s[32:35], s13 offen offset:1024 lds
  buffer_load_dwordx4 v2, s[32:35], s13 offen offset:2048 lds
  buffer_load_dwordx4 v2, s[32:35], s13 offen offset:3072 lds
  s_mov_b32 m0, s50
  s_mov_b32 exec_hi, 0
  buffer_load_dword v4, s[32:35], s51 offen lds
  s_mov_b32 exec_hi, -1
  s_add_u32 s51, s51, 4
  s_add_u32 s12, s12, 49152
  s_barrier
  s_and_b32 s11, s11, 31
  s_mul_i32 s13, s11, 12288
  s_add_u32 s13, s13, s10
  s_add_u32 s11, s11, 4
  s_add_u32 m0, s12, 0
  s_nop 0
  buffer_load_dwordx4 v2, s[32:35], s13 offen offset:0 lds
  buffer_load_dwordx4 v2, s[32:35], s13 offen offset:1024 lds
  buffer_load_dwordx4 v2, s[32:35], s13 offen offset:2048 lds
  buffer_load_dwordx4 v2, s[32:35], s13 offen offset:3072 lds
  s_add_u32 s13, s13, 4096
  s_add_u32 m0, s12, 4096
  s_nop 0
  buffer_load_dwordx4 v2, s[32:35], s13 offen offset:0 lds
  buffer_load_dwordx4 v2, s[32:35], s13 offen offset:1024 lds
  buffer_load_dwordx4 v2, s[32:35], s13 offen offset:2048 lds
  buffer_load_dwordx4 v2, s[32:35], s13 offen offset:3072 lds
  s_add_u32 s13, s13, 4096
  s_add_u32 m0, s12, 8192
  s_nop 0
  buffer_load_dwordx4 v2, s[32:35], s13 offen offset:0 lds
  buffer_load_dwordx4 v2, s[32:35], s13 offen offset:1024 lds
  buffer_load_dwordx4 v2, s[32:35], s13 offen offset:2048 lds
  buffer_load_dwordx4 v2, s[32:35], s13 offen offset:3072 lds
  s_mov_b32 m0, s50
  s_mov_b32 exec_hi, 0
  buffer_load_dword v4, s[32:35], s51 offen lds
  s_mov_b32 exec_hi, -1
  s_add_u32 s51, s51, 4
  s_add_u32 s12, s12, 49152
  s_barrier
  s_and_b32 s11, s11, 31
  s_mul_i32 s13, s11, 12288
.Lk2_pad7:
  s_cbranch_execz k1_exit
  s_add_u32 s13, s13, s10
  s_add_u32 s11, s11, 4
  s_add_u32 m0, s12, 0
  s_nop 0
  buffer_load_dwordx4 v2, s[32:35], s13 offen offset:0 lds
  buffer_load_dwordx4 v2, s[32:35], s13 offen offset:1024 lds
  buffer_load_dwordx4 v2, s[32:35], s13 offen offset:2048 lds
  buffer_load_dwordx4 v2, s[32:35], s13 offen offset:3072 lds
  s_add_u32 s13, s13, 4096
  s_add_u32 m0, s12, 4096
  s_nop 0
  buffer_load_dwordx4 v2, s[32:35], s13 offen offset:0 lds
  buffer_load_dwordx4 v2, s[32:35], s13 offen offset:1024 lds
  buffer_load_dwordx4 v2, s[32:35], s13 offen offset:2048 lds
  buffer_load_dwordx4 v2, s[32:35], s13 offen offset:3072 lds
  s_add_u32 s13, s13, 4096
  s_add_u32 m0, s12, 8192
  s_nop 0
  buffer_load_dwordx4 v2, s[32:35], s13 offen offset:0 lds
  buffer_load_dwordx4 v2, s[32:35], s13 offen offset:1024 lds
  buffer_load_dwordx4 v2, s[32:35], s13 offen offset:2048 lds
  buffer_load_dwordx4 v2, s[32:35], s13 offen offset:3072 lds
  s_mov_b32 m0, s50
  s_mov_b32 exec_hi, 0
  buffer_load_dword v4, s[32:35], s51 offen lds
  s_mov_b32 exec_hi, -1
  s_add_u32 s51, s51, 4
  s_add_u32 s12, s12, 4294868992
  s_barrier
  s_and_b32 s11, s11, 31
  s_mul_i32 s13, s11, 12288
  s_add_u32 s13, s13, s10
  s_add_u32 s11, s11, 4
  s_add_u32 m0, s12, 0
  s_nop 0
  buffer_load_dwordx4 v2, s[32:35], s13 offen offset:0 lds
  buffer_load_dwordx4 v2, s[32:35], s13 offen offset:1024 lds
  buffer_load_dwordx4 v2, s[32:35], s13 offen offset:2048 lds
  buffer_load_dwordx4 v2, s[32:35], s13 offen offset:3072 lds
  s_add_u32 s13, s13, 4096
  s_add_u32 m0, s12, 4096
  s_nop 0
  buffer_load_dwordx4 v2, s[32:35], s13 offen offset:0 lds
  buffer_load_dwordx4 v2, s[32:35], s13 offen offset:1024 lds
  buffer_load_dwordx4 v2, s[32:35], s13 offen offset:2048 lds
  buffer_load_dwordx4 v2, s[32:35], s13 offen offset:3072 lds
  s_add_u32 s13, s13, 4096
  s_add_u32 m0, s12, 8192
  s_nop 0
  buffer_load_dwordx4 v2, s[32:35], s13 offen offset:0 lds
  buffer_load_dwordx4 v2, s[32:35], s13 offen offset:1024 lds
  buffer_load_dwordx4 v2, s[32:35], s13 offen offset:2048 lds
  buffer_load_dwordx4 v2, s[32:35], s13 offen offset:3072 lds
  s_mov_b32 m0, s50
  s_mov_b32 exec_hi, 0
  buffer_load_dword v4, s[32:35], s51 offen lds
  s_mov_b32 exec_hi, -1
  s_add_u32 s51, s51, 4
  s_add_u32 s12, s12, 49152
  s_barrier
  s_and_b32 s11, s11, 31
  s_mul_i32 s13, s11, 12288
  s_add_u32 s13, s13, s10
  s_add_u32 s11, s11, 4
  s_add_u32 m0, s12, 0
  s_nop 0
  buffer_load_dwordx4 v2, s[32:35], s13 offen offset:0 lds
  buffer_load_dwordx4 v2, s[32:35], s13 offen offset:1024 lds
  buffer_load_dwordx4 v2, s[32:35], s13 offen offset:2048 lds
  buffer_load_dwordx4 v2, s[32:35], s13 offen offset:3072 lds
  s_add_u32 s13, s13, 4096
  s_add_u32 m0, s12, 4096
  s_nop 0
  buffer_load_dwordx4 v2, s[32:35], s13 offen offset:0 lds
  buffer_load_dwordx4 v2, s[32:35], s13 offen offset:1024 lds
  buffer_load_dwordx4 v2, s[32:35], s13 offen offset:2048 lds
  buffer_load_dwordx4 v2, s[32:35], s13 offen offset:3072 lds
  s_add_u32 s13, s13, 4096
  s_add_u32 m0, s12, 8192
  s_nop 0
  buffer_load_dwordx4 v2, s[32:35], s13 offen offset:0 lds
  buffer_load_dwordx4 v2, s[32:35], s13 offen offset:1024 lds
  buffer_load_dwordx4 v2, s[32:35], s13 offen offset:2048 lds
  buffer_load_dwordx4 v2, s[32:35], s13 offen offset:3072 lds
  s_add_u32 s51, s51, 4
  s_mov_b32 m0, s50
  s_mov_b32 exec_hi, 0
  buffer_load_dword v4, s[32:35], s51 offen lds
  s_mov_b32 exec_hi, -1
  s_add_u32 s51, s51, 4
  s_mov_b32 s36, s26
  s_mov_b32 s37, s27
  s_mov_b32 s38, 3145728
  s_mov_b32 s39, 0x00020000
  s_lshl_b32 s14, s4, 10
  s_lshl_b32 s9, s5, 5
  s_add_u32 s14, s14, s9
  s_lshl_b32 s8, s14, 3
  s_add_u32 s15, s8, 3145728
  s_mul_i32 s8, s5, 12288
  s_add_u32 s13, s8, s10
  s_mul_i32 s14, s14, 384
  s_mul_i32 s9, s7, 3072
  s_add_u32 s14, s14, s9
  s_barrier
  buffer_load_dwordx2 v[6:7], v19, s[32:35], s15 offen
  buffer_load_dwordx2 v[8:9], v19, s[32:35], s15 offen offset:128
  buffer_load_dwordx2 v[20:21], v12, s[32:35], s13 offen offset:0
  buffer_load_dwordx2 v[22:23], v12, s[32:35], s13 offen offset:256
  buffer_load_dwordx2 v[24:25], v13, s[32:35], s13 offen offset:0
  buffer_load_dwordx2 v[26:27], v13, s[32:35], s13 offen offset:256
  buffer_load_dwordx2 v[28:29], v14, s[32:35], s13 offen offset:0
  buffer_load_dwordx2 v[30:31], v14, s[32:35], s13 offen offset:256
  buffer_load_dwordx4 v[72:75], v2, s[32:35], s60 offen offset:2048
  buffer_load_dwordx4 v[96:99], v2, s[32:35], s62 offen offset:0
  buffer_load_dwordx4 v[120:123], v2, s[32:35], s63 offen offset:2048
  buffer_load_dwordx4 v[76:79], v2, s[32:35], s60 offen offset:3072
  buffer_load_dwordx4 v[100:103], v2, s[32:35], s62 offen offset:1024
  buffer_load_dwordx4 v[124:127], v2, s[32:35], s63 offen offset:3072
  s_barrier
  buffer_load_dwordx4 v[80:83], v2, s[32:35], s61 offen offset:0
  buffer_load_dwordx4 v[104:107], v2, s[32:35], s62 offen offset:2048
  s_add_u32 s8, s63, 4096
  buffer_load_dwordx4 v[128:131], v2, s[32:35], s8 offen offset:0
  buffer_load_dwordx4 v[84:87], v2, s[32:35], s61 offen offset:1024
  buffer_load_dwordx4 v[108:111], v2, s[32:35], s62 offen offset:3072
  s_add_u32 s8, s63, 4096
  buffer_load_dwordx4 v[132:135], v2, s[32:35], s8 offen offset:1024
  s_waitcnt vmcnt(17)
  v_lshlrev_b32 v32, 16, v20
  v_and_b32 v33, 0xffff0000, v20
  v_lshlrev_b32_e64 v34, 16, v21
  v_and_b32 v35, 0xffff0000, v21
  v_fma_f32 v32, v32, v7, v6
  v_fma_f32 v33, v33, v7, v6
  v_fma_f32 v34, v34, v7, v6
  v_fma_f32 v35, v35, v7, v6
  s_waitcnt vmcnt(16)
  v_lshlrev_b32 v36, 16, v22
  v_and_b32 v37, 0xffff0000, v22
  v_lshlrev_b32_e64 v38, 16, v23
  v_and_b32 v39, 0xffff0000, v23
  v_fma_f32 v36, v36, v9, v8
  v_fma_f32 v37, v37, v9, v8
  v_fma_f32 v38, v38, v9, v8
  v_fma_f32 v39, v39, v9, v8
  s_waitcnt vmcnt(15)
  v_lshlrev_b32 v40, 16, v24
  v_and_b32 v41, 0xffff0000, v24
  v_lshlrev_b32_e64 v42, 16, v25
  v_and_b32 v43, 0xffff0000, v25
  v_fma_f32 v40, v40, v7, v6
  v_fma_f32 v41, v41, v7, v6
.Lk2_pad8:
  s_cbranch_execz k1_exit
  v_fma_f32 v42, v42, v7, v6
  v_fma_f32 v43, v43, v7, v6
  s_waitcnt vmcnt(14)
  v_lshlrev_b32_e64 v44, 16, v26
  v_and_b32 v45, 0xffff0000, v26
  v_lshlrev_b32_e64 v46, 16, v27
  v_and_b32 v47, 0xffff0000, v27
  v_fma_f32 v44, v44, v9, v8
  v_fma_f32 v45, v45, v9, v8
  v_fma_f32 v46, v46, v9, v8
  v_fma_f32 v47, v47, v9, v8
  s_waitcnt vmcnt(13)
  v_lshlrev_b32 v48, 16, v28
  v_and_b32 v49, 0xffff0000, v28
  v_lshlrev_b32_e64 v50, 16, v29
  v_and_b32 v51, 0xffff0000, v29
  v_fma_f32 v48, v48, v7, v6
  v_fma_f32 v49, v49, v7, v6
  v_fma_f32 v50, v50, v7, v6
  v_fma_f32 v51, v51, v7, v6
  s_waitcnt vmcnt(12)
  v_lshlrev_b32 v52, 16, v30
  v_and_b32 v53, 0xffff0000, v30
  v_lshlrev_b32_e64 v54, 16, v31
  v_and_b32 v55, 0xffff0000, v31
  v_fma_f32 v52, v52, v9, v8
  v_fma_f32 v53, v53, v9, v8
  v_fma_f32 v54, v54, v9, v8
  v_fma_f32 v55, v55, v9, v8
  s_cmp_eq_u32 s44, 0
  s_cbranch_scc1 k2_lnom
  s_barrier
k2_lnom:
  s_barrier
  ds_read_b128 v[200:203], v18 offset:0
  ds_read_b128 v[204:207], v18 offset:16
  ds_read_b128 v[208:211], v18 offset:512
  ds_read_b128 v[212:215], v18 offset:528
  s_waitcnt lgkmcnt(3)
  v_add_f32 v200, v200, v201
  v_add_f32 v202, v202, v203
  s_waitcnt lgkmcnt(2)
  v_add_f32 v204, v204, v205
  v_add_f32 v206, v206, v207
  v_add_f32 v200, v200, v202
  v_add_f32 v204, v204, v206
  v_add_f32 v200, v200, v204
  s_waitcnt lgkmcnt(1)
  v_add_f32 v208, v208, v209
  v_add_f32 v210, v210, v211
  s_waitcnt lgkmcnt(0)
  v_add_f32 v212, v212, v213
  v_add_f32 v214, v214, v215
  v_add_f32 v208, v208, v210
  v_add_f32 v212, v212, v214
  v_add_f32 v208, v208, v212
  s_mov_b32 s8, 0x5d800000
  s_mov_b32 s9, 0x21800000
  s_mov_b64 s[12:13], 0
  v_cmp_nge_f32 vcc, s8, v200
  v_cmp_nle_f32 s[10:11], s9, v200
  s_or_b64 s[12:13], s[12:13], vcc
  s_or_b64 s[12:13], s[12:13], s[10:11]
  v_cmp_nge_f32 vcc, s8, v208
  v_cmp_nle_f32 s[10:11], s9, v208
  s_or_b64 s[12:13], s[12:13], vcc
  s_or_b64 s[12:13], s[12:13], s[10:11]
  s_cmp_lg_u64 s[12:13], 0
  s_cselect_b32 s8, 1, 0
  s_cmp_eq_u32 s44, 0
  s_cselect_b32 s45, s8, 0
  v_rcp_f32 v200, v200
  v_rcp_f32 v208, v208
  s_barrier
  s_cmp_lg_u32 s45, 0
  s_cbranch_scc1 k2_lrestart
  ds_read_b128 v[136:139], v16 offset:0
  ds_read_b128 v[140:143], v16 offset:256
  ds_read_b128 v[144:147], v16 offset:2048
  ds_read_b128 v[148:151], v16 offset:2304
  ds_read_b128 v[152:155], v16 offset:4096
  ds_read_b128 v[156:159], v16 offset:4352
  ds_read_b128 v[160:163], v16 offset:6144
  ds_read_b128 v[164:167], v16 offset:6400
  ds_read_b128 v[168:171], v16 offset:8192
  ds_read_b128 v[172:175], v16 offset:8448
  ds_read_b128 v[176:179], v16 offset:10240
  ds_read_b128 v[180:183], v16 offset:10496
  s_waitcnt lgkmcnt(11)
  v_mfma_f32_16x16x32_bf16 v[216:219], v[64:67], v[136:139], 0
  s_waitcnt lgkmcnt(10)
  v_mfma_f32_16x16x32_bf16 v[220:223], v[64:67], v[140:143], 0
  v_mfma_f32_16x16x32_bf16 v[224:227], v[88:91], v[136:139], 0
  v_mfma_f32_16x16x32_bf16 v[228:231], v[88:91], v[140:143], 0
  v_mfma_f32_16x16x32_bf16 v[232:235], v[112:115], v[136:139], 0
  v_mfma_f32_16x16x32_bf16 v[236:239], v[112:115], v[140:143], 0
  s_waitcnt lgkmcnt(9)
  v_mfma_f32_16x16x32_bf16 v[216:219], v[68:71], v[144:147], v[216:219]
  s_waitcnt lgkmcnt(8)
  v_mfma_f32_16x16x32_bf16 v[220:223], v[68:71], v[148:151], v[220:223]
  v_mfma_f32_16x16x32_bf16 v[224:227], v[92:95], v[144:147], v[224:227]
  v_mfma_f32_16x16x32_bf16 v[228:231], v[92:95], v[148:151], v[228:231]
  v_mfma_f32_16x16x32_bf16 v[232:235], v[116:119], v[144:147], v[232:235]
  v_mfma_f32_16x16x32_bf16 v[236:239], v[116:119], v[148:151], v[236:239]
  s_waitcnt vmcnt(11) lgkmcnt(7)
  v_mfma_f32_16x16x32_bf16 v[216:219], v[72:75], v[152:155], v[216:219]
  s_waitcnt lgkmcnt(6)
  v_mfma_f32_16x16x32_bf16 v[220:223], v[72:75], v[156:159], v[220:223]
  s_waitcnt vmcnt(10)
  v_mfma_f32_16x16x32_bf16 v[224:227], v[96:99], v[152:155], v[224:227]
  v_mfma_f32_16x16x32_bf16 v[228:231], v[96:99], v[156:159], v[228:231]
  s_waitcnt vmcnt(9)
  v_mfma_f32_16x16x32_bf16 v[232:235], v[120:123], v[152:155], v[232:235]
  v_mfma_f32_16x16x32_bf16 v[236:239], v[120:123], v[156:159], v[236:239]
  s_waitcnt vmcnt(8) lgkmcnt(5)
  v_mfma_f32_16x16x32_bf16 v[216:219], v[76:79], v[160:163], v[216:219]
  s_waitcnt lgkmcnt(4)
  v_mfma_f32_16x16x32_bf16 v[220:223], v[76:79], v[164:167], v[220:223]
  s_waitcnt vmcnt(5) lgkmcnt(3)
  v_mfma_f32_16x16x32_bf16 v[216:219], v[80:83], v[168:171], v[216:219]
  s_waitcnt lgkmcnt(2)
  v_mfma_f32_16x16x32_bf16 v[220:223], v[80:83], v[172:175], v[220:223]
  s_waitcnt vmcnt(2) lgkmcnt(1)
  v_mfma_f32_16x16x32_bf16 v[216:219], v[84:87], v[176:179], v[216:219]
  s_waitcnt lgkmcnt(0)
  v_mfma_f32_16x16x32_bf16 v[220:223], v[84:87], v[180:183], v[220:223]
  v_mfma_f32_16x16x32_bf16 v[224:227], v[100:103], v[160:163], v[224:227]
  v_mfma_f32_16x16x32_bf16 v[228:231], v[100:103], v[164:167], v[228:231]
  v_fma_f32 v32, v216, v200, v32
  v_fma_f32 v33, v217, v200, v33
  v_fma_f32 v34, v218, v200, v34
  v_fma_f32 v35, v219, v200, v35
  v_mfma_f32_16x16x32_bf16 v[224:227], v[104:107], v[168:171], v[224:227]
  v_fma_f32 v36, v220, v208, v36
  v_fma_f32 v37, v221, v208, v37
  v_fma_f32 v38, v222, v208, v38
  v_fma_f32 v39, v223, v208, v39
  v_mfma_f32_16x16x32_bf16 v[228:231], v[104:107], v[172:175], v[228:231]
  v_cvt_pk_bf16_f32 v20, v32, v33
  v_cvt_pk_bf16_f32 v21, v34, v35
  v_cvt_pk_bf16_f32 v22, v36, v37
  v_cvt_pk_bf16_f32 v23, v38, v39
  s_waitcnt vmcnt(1)
  v_mfma_f32_16x16x32_bf16 v[224:227], v[108:111], v[176:179], v[224:227]
  v_permlane16_swap_b32 v20, v22
  v_permlane16_swap_b32 v21, v23
  s_nop 0
  ds_write_b128 v56, v[20:23] offset:0
  v_mfma_f32_16x16x32_bf16 v[228:231], v[108:111], v[180:183], v[228:231]
  v_mfma_f32_16x16x32_bf16 v[232:235], v[124:127], v[160:163], v[232:235]
  v_mfma_f32_16x16x32_bf16 v[236:239], v[124:127], v[164:167], v[236:239]
  v_fma_f32 v40, v224, v200, v40
  v_fma_f32 v41, v225, v200, v41
  v_fma_f32 v42, v226, v200, v42
  v_fma_f32 v43, v227, v200, v43
  v_mfma_f32_16x16x32_bf16 v[232:235], v[128:131], v[168:171], v[232:235]
  v_fma_f32 v44, v228, v208, v44
  v_fma_f32 v45, v229, v208, v45
  v_fma_f32 v46, v230, v208, v46
.Lk2_pad9:
  s_cbranch_execz k1_exit
  s_nop 0
  v_fma_f32 v47, v231, v208, v47
  v_mfma_f32_16x16x32_bf16 v[236:239], v[128:131], v[172:175], v[236:239]
  v_cvt_pk_bf16_f32 v24, v40, v41
  v_cvt_pk_bf16_f32 v25, v42, v43
  v_cvt_pk_bf16_f32 v26, v44, v45
  v_cvt_pk_bf16_f32 v27, v46, v47
  s_waitcnt vmcnt(0)
  v_mfma_f32_16x16x32_bf16 v[232:235], v[132:135], v[176:179], v[232:235]
  v_permlane16_swap_b32 v24, v26
  v_permlane16_swap_b32 v25, v27
  ds_write_b128 v56, v[24:27] offset:32
  v_mfma_f32_16x16x32_bf16 v[236:239], v[132:135], v[180:183], v[236:239]
  s_nop 3
  v_fma_f32 v48, v232, v200, v48
  v_fma_f32 v49, v233, v200, v49
  v_fma_f32 v50, v234, v200, v50
  v_fma_f32 v51, v235, v200, v51
  v_fma_f32 v52, v236, v208, v52
  v_fma_f32 v53, v237, v208, v53
  v_fma_f32 v54, v238, v208, v54
  v_fma_f32 v55, v239, v208, v55
  v_cvt_pk_bf16_f32 v28, v48, v49
  v_cvt_pk_bf16_f32 v29, v50, v51
  v_cvt_pk_bf16_f32 v30, v52, v53
  v_cvt_pk_bf16_f32 v31, v54, v55
  s_nop 0
  v_permlane16_swap_b32 v28, v30
  v_permlane16_swap_b32 v29, v31
  ds_write_b128 v56, v[28:31] offset:64
  s_waitcnt lgkmcnt(0)
  s_barrier
  ds_read_b128 v[20:23], v57
  ds_read_b128 v[24:27], v58
  ds_read_b128 v[28:31], v59
  s_waitcnt lgkmcnt(2)
  buffer_store_dwordx4 v[20:23], v17, s[36:39], s14 offen offset:0 sc1
  s_waitcnt lgkmcnt(1)
  buffer_store_dwordx4 v[24:27], v17, s[36:39], s14 offen offset:1024 sc1
  s_waitcnt lgkmcnt(0)
  buffer_store_dwordx4 v[28:31], v17, s[36:39], s14 offen offset:2048 sc1
k2_exit:
  s_endpgm
k2_lrestart:
  s_waitcnt vmcnt(0)
  s_mov_b32 s44, 1
  s_branch k2_lstart
k2_slow:
  v_mov_b32 v168, 0xff800000
k2_sloop:
  s_waitcnt lgkmcnt(3)
  v_mfma_f32_32x32x16_bf16 v[152:167], v[192:195], v[104:107], 0
  s_waitcnt lgkmcnt(2)
  v_mfma_f32_32x32x16_bf16 v[152:167], v[196:199], v[108:111], v[152:167]
  s_waitcnt lgkmcnt(1)
  v_mfma_f32_32x32x16_bf16 v[152:167], v[200:203], v[112:115], v[152:167]
  s_waitcnt lgkmcnt(0)
  v_mfma_f32_32x32x16_bf16 v[152:167], v[204:207], v[116:119], v[152:167]
  ds_read_b128 v[192:195], v0 offset:4096
  s_waitcnt lgkmcnt(0)
  v_mfma_f32_32x32x16_bf16 v[152:167], v[192:195], v[120:123], v[152:167]
  ds_read_b128 v[196:199], v1 offset:5120
  s_waitcnt lgkmcnt(0)
  v_mfma_f32_32x32x16_bf16 v[152:167], v[196:199], v[124:127], v[152:167]
  ds_read_b128 v[200:203], v0 offset:6144
  s_waitcnt lgkmcnt(0)
  v_mfma_f32_32x32x16_bf16 v[152:167], v[200:203], v[128:131], v[152:167]
  ds_read_b128 v[204:207], v1 offset:7168
  s_waitcnt lgkmcnt(0)
  v_mfma_f32_32x32x16_bf16 v[152:167], v[204:207], v[132:135], v[152:167]
  ds_read_b128 v[192:195], v0 offset:8192
  s_waitcnt lgkmcnt(0)
  v_mfma_f32_32x32x16_bf16 v[152:167], v[192:195], v[136:139], v[152:167]
  ds_read_b128 v[196:199], v1 offset:9216
  s_waitcnt lgkmcnt(0)
  v_mfma_f32_32x32x16_bf16 v[152:167], v[196:199], v[140:143], v[152:167]
  ds_read_b128 v[200:203], v0 offset:10240
  s_waitcnt lgkmcnt(0)
  v_mfma_f32_32x32x16_bf16 v[152:167], v[200:203], v[144:147], v[152:167]
  ds_read_b128 v[204:207], v1 offset:11264
  s_waitcnt lgkmcnt(0)
  v_mfma_f32_32x32x16_bf16 v[152:167], v[204:207], v[148:151], v[152:167]
  s_nop 11
  s_nop 0
  v_max3_f32 v169, v152, v153, v154
  v_max3_f32 v169, v169, v155, v156
  v_max3_f32 v169, v169, v157, v158
  v_max3_f32 v169, v169, v159, v160
  v_max3_f32 v169, v169, v161, v162
  v_max3_f32 v169, v169, v163, v164
  v_max3_f32 v169, v169, v165, v166
  v_max_f32 v169, v169, v167
  v_mov_b32 v170, v169
  s_nop 1
  v_permlane32_swap_b32 v169, v170
  v_max_f32 v169, v169, v170
  v_max_f32 v169, v169, v168
  v_sub_f32 v170, v168, v169
  v_exp_f32 v170, v170
  v_mov_b32 v168, v169
  v_sub_f32 v152, v152, v169
  v_sub_f32 v153, v153, v169
  v_sub_f32 v154, v154, v169
  v_sub_f32 v155, v155, v169
  v_sub_f32 v156, v156, v169
  v_sub_f32 v157, v157, v169
  v_sub_f32 v158, v158, v169
  v_sub_f32 v159, v159, v169
  v_sub_f32 v160, v160, v169
  v_sub_f32 v161, v161, v169
  v_sub_f32 v162, v162, v169
  v_sub_f32 v163, v163, v169
  v_sub_f32 v164, v164, v169
  v_sub_f32 v165, v165, v169
  v_sub_f32 v166, v166, v169
  v_sub_f32 v167, v167, v169
  v_exp_f32 v152, v152
  v_exp_f32 v153, v153
  v_exp_f32 v154, v154
  v_exp_f32 v155, v155
  v_exp_f32 v160, v160
  v_exp_f32 v161, v161
  v_exp_f32 v162, v162
  v_exp_f32 v163, v163
  v_exp_f32 v156, v156
  v_exp_f32 v157, v157
  v_exp_f32 v158, v158
  v_exp_f32 v159, v159
  v_exp_f32 v164, v164
  v_exp_f32 v165, v165
  v_exp_f32 v166, v166
  v_exp_f32 v167, v167
  v_mul_f32 v4, v4, v170
  v_add_f32 v4, v4, v152
  v_add_f32 v4, v4, v153
  v_add_f32 v4, v4, v154
  v_add_f32 v4, v4, v155
  v_add_f32 v4, v4, v160
  v_add_f32 v4, v4, v161
  v_add_f32 v4, v4, v162
  v_add_f32 v4, v4, v163
  v_add_f32 v4, v4, v156
  v_add_f32 v4, v4, v157
  v_add_f32 v4, v4, v158
  v_add_f32 v4, v4, v159
  v_add_f32 v4, v4, v164
  v_add_f32 v4, v4, v165
  v_add_f32 v4, v4, v166
  v_add_f32 v4, v4, v167
  v_cvt_pk_bf16_f32 v184, v152, v153
  v_cvt_pk_bf16_f32 v185, v154, v155
  v_cvt_pk_bf16_f32 v186, v160, v161
  v_cvt_pk_bf16_f32 v187, v162, v163
  v_cvt_pk_bf16_f32 v188, v156, v157
  v_cvt_pk_bf16_f32 v189, v158, v159
  v_cvt_pk_bf16_f32 v190, v164, v165
  v_cvt_pk_bf16_f32 v191, v166, v167
  v_mul_f32 v8, v8, v170
  v_mul_f32 v9, v9, v170
  v_mul_f32 v10, v10, v170
  v_mul_f32 v11, v11, v170
  v_mul_f32 v12, v12, v170
  v_mul_f32 v13, v13, v170
  v_mul_f32 v14, v14, v170
  v_mul_f32 v15, v15, v170
  v_mul_f32 v16, v16, v170
  v_mul_f32 v17, v17, v170
  v_mul_f32 v18, v18, v170
  v_mul_f32 v19, v19, v170
  v_mul_f32 v20, v20, v170
  v_mul_f32 v21, v21, v170
  v_mul_f32 v22, v22, v170
  v_mul_f32 v23, v23, v170
  v_mul_f32 v24, v24, v170
  v_mul_f32 v25, v25, v170
  v_mul_f32 v26, v26, v170
  v_mul_f32 v27, v27, v170
  v_mul_f32 v28, v28, v170
  v_mul_f32 v29, v29, v170
  v_mul_f32 v30, v30, v170
  v_mul_f32 v31, v31, v170
  v_mul_f32 v32, v32, v170
  v_mul_f32 v33, v33, v170
  v_mul_f32 v34, v34, v170
  v_mul_f32 v35, v35, v170
  v_mul_f32 v36, v36, v170
  v_mul_f32 v37, v37, v170
  v_mul_f32 v38, v38, v170
  v_mul_f32 v39, v39, v170
  v_mul_f32 v40, v40, v170
  v_mul_f32 v41, v41, v170
  v_mul_f32 v42, v42, v170
  v_mul_f32 v43, v43, v170
  v_mul_f32 v44, v44, v170
  v_mul_f32 v45, v45, v170
  v_mul_f32 v46, v46, v170
  v_mul_f32 v47, v47, v170
  v_mul_f32 v48, v48, v170
  v_mul_f32 v49, v49, v170
  v_mul_f32 v50, v50, v170
  v_mul_f32 v51, v51, v170
  v_mul_f32 v52, v52, v170
  v_mul_f32 v53, v53, v170
  v_mul_f32 v54, v54, v170
  v_mul_f32 v55, v55, v170
  v_mul_f32 v56, v56, v170
  v_mul_f32 v57, v57, v170
  v_mul_f32 v58, v58, v170
  v_mul_f32 v59, v59, v170
  v_mul_f32 v60, v60, v170
  v_mul_f32 v61, v61, v170
  v_mul_f32 v62, v62, v170
  v_mul_f32 v63, v63, v170
  v_mul_f32 v64, v64, v170
  v_mul_f32 v65, v65, v170
  v_mul_f32 v66, v66, v170
  v_mul_f32 v67, v67, v170
  v_mul_f32 v68, v68, v170
  v_mul_f32 v69, v69, v170
  v_mul_f32 v70, v70, v170
  v_mul_f32 v71, v71, v170
  v_mul_f32 v72, v72, v170
  v_mul_f32 v73, v73, v170
  v_mul_f32 v74, v74, v170
  v_mul_f32 v75, v75, v170
  v_mul_f32 v76, v76, v170
  v_mul_f32 v77, v77, v170
  v_mul_f32 v78, v78, v170
  v_mul_f32 v79, v79, v170
  v_mul_f32 v80, v80, v170
  v_mul_f32 v81, v81, v170
  v_mul_f32 v82, v82, v170
  v_mul_f32 v83, v83, v170
  v_mul_f32 v84, v84, v170
  v_mul_f32 v85, v85, v170
  v_mul_f32 v86, v86, v170
  v_mul_f32 v87, v87, v170
  v_mul_f32 v88, v88, v170
  v_mul_f32 v89, v89, v170
  v_mul_f32 v90, v90, v170
  v_mul_f32 v91, v91, v170
  v_mul_f32 v92, v92, v170
  v_mul_f32 v93, v93, v170
  v_mul_f32 v94, v94, v170
  v_mul_f32 v95, v95, v170
  v_mul_f32 v96, v96, v170
  v_mul_f32 v97, v97, v170
  v_mul_f32 v98, v98, v170
  v_mul_f32 v99, v99, v170
  v_mul_f32 v100, v100, v170
  v_mul_f32 v101, v101, v170
  v_mul_f32 v102, v102, v170
  v_mul_f32 v103, v103, v170
  ds_read_b64_tr_b16 v[208:209], v2 offset:0
  ds_read_b64_tr_b16 v[210:211], v2 offset:256
  ds_read_b64_tr_b16 v[212:213], v3 offset:0
  ds_read_b64_tr_b16 v[214:215], v3 offset:256
  ds_read_b64_tr_b16 v[216:217], v2 offset:2048
  ds_read_b64_tr_b16 v[218:219], v2 offset:2304
  ds_read_b64_tr_b16 v[220:221], v3 offset:2048
  ds_read_b64_tr_b16 v[222:223], v3 offset:2304
  ds_read_b64_tr_b16 v[224:225], v2 offset:4096
  ds_read_b64_tr_b16 v[226:227], v2 offset:4352
  ds_read_b64_tr_b16 v[228:229], v3 offset:4096
  ds_read_b64_tr_b16 v[230:231], v3 offset:4352
  ds_read_b64_tr_b16 v[232:233], v2 offset:6144
  ds_read_b64_tr_b16 v[234:235], v2 offset:6400
  ds_read_b64_tr_b16 v[236:237], v3 offset:6144
  ds_read_b64_tr_b16 v[238:239], v3 offset:6400
  ds_read_b64_tr_b16 v[240:241], v2 offset:8192
  ds_read_b64_tr_b16 v[242:243], v2 offset:8448
  ds_read_b64_tr_b16 v[244:245], v3 offset:8192
  ds_read_b64_tr_b16 v[246:247], v3 offset:8448
  ds_read_b64_tr_b16 v[248:249], v2 offset:10240
  ds_read_b64_tr_b16 v[250:251], v2 offset:10496
  ds_read_b64_tr_b16 v[252:253], v3 offset:10240
  ds_read_b64_tr_b16 v[254:255], v3 offset:10496
  s_cmp_eq_u32 s48, 9
  s_cbranch_scc1 k2_snox
  s_waitcnt lgkmcnt(0)
  s_barrier
k2_snox:
  s_waitcnt lgkmcnt(15)
  v_mfma_f32_32x32x16_bf16 v[8:23], v[208:211], v[184:187], v[8:23]
  v_mfma_f32_32x32x16_bf16 v[8:23], v[212:215], v[188:191], v[8:23]
  v_mfma_f32_32x32x16_bf16 v[24:39], v[216:219], v[184:187], v[24:39]
  v_mfma_f32_32x32x16_bf16 v[24:39], v[220:223], v[188:191], v[24:39]
  s_waitcnt lgkmcnt(14)
  v_mfma_f32_32x32x16_bf16 v[40:55], v[224:227], v[184:187], v[40:55]
  s_waitcnt lgkmcnt(12)
  v_mfma_f32_32x32x16_bf16 v[40:55], v[228:231], v[188:191], v[40:55]
  s_waitcnt lgkmcnt(10)
  v_mfma_f32_32x32x16_bf16 v[56:71], v[232:235], v[184:187], v[56:71]
  s_waitcnt lgkmcnt(8)
  v_mfma_f32_32x32x16_bf16 v[56:71], v[236:239], v[188:191], v[56:71]
  s_waitcnt lgkmcnt(6)
  v_mfma_f32_32x32x16_bf16 v[72:87], v[240:243], v[184:187], v[72:87]
  s_waitcnt lgkmcnt(4)
  v_mfma_f32_32x32x16_bf16 v[72:87], v[244:247], v[188:191], v[72:87]
  s_waitcnt lgkmcnt(2)
  v_mfma_f32_32x32x16_bf16 v[88:103], v[248:251], v[184:187], v[88:103]
  s_waitcnt lgkmcnt(0)
  v_mfma_f32_32x32x16_bf16 v[88:103], v[252:255], v[188:191], v[88:103]
  s_cmp_eq_u32 s48, 9
  s_cbranch_scc1 k2_sdone
k2_spoll:
  s_sub_u32 s49, s49, 1
  s_cbranch_scc1 k2_exit
  ds_read_b32 v7, v5 offset:384
  s_waitcnt lgkmcnt(0)
  v_cmp_gt_u32 vcc, s48, v7
  s_nop 0
  s_cbranch_vccnz k2_spoll
  s_add_u32 s48, s48, 1
  v_add_u32 v0, s42, v0
  v_add_u32 v1, s42, v1
  v_add_u32 v2, s42, v2
  v_add_u32 v3, s42, v3
  s_add_u32 s43, s43, 1
  s_cmp_eq_u32 s43, 3
  s_cselect_b32 s42, s41, s40
  s_cselect_b32 s43, 0, s43
  ds_read_b128 v[192:195], v0 offset:0
  ds_read_b128 v[196:199], v1 offset:1024
  ds_read_b128 v[200:203], v0 offset:2048
  ds_read_b128 v[204:207], v1 offset:3072
  s_branch k2_sloop
k2_sdone:
  v_add_u32 v140, s52, v6
  v_add_u32 v141, s53, v6
  v_add_u32 v142, s54, v6
  v_add_u32_e64 v143, s55, v6
  v_bfe_u32 v147, v6, 3, 5
  v_lshrrev_b32 v148, 8, v6
  v_lshlrev_b32 v146, 5, v147
  v_lshl_add_u32 v145, v148, 2, v146
  v_add_u32 v145, s58, v145
  v_add_u32 v146, s59, v146
  v_xor_b32 v144, s57, v147
  v_lshlrev_b32 v144, 4, v144
  v_lshl_add_u32 v144, v148, 3, v144
  v_add_u32 v144, s56, v144
  v_lshlrev_b32 v3, 4, v147
  v_add_u32 v3, 162816, v3
  v_add_u32_e64 v169, s57, v3
  ds_write_b32 v169, v168
  s_waitcnt lgkmcnt(0)
  s_barrier
  ds_read_b128 v[192:195], v3
  s_waitcnt lgkmcnt(0)
  v_max3_f32 v169, v192, v193, v194
  v_max_f32 v169, v169, v195
  v_sub_f32 v170, v168, v169
  v_exp_f32 v170, v170
  s_nop 0
  v_mul_f32 v4, v4, v170
  v_mul_f32 v8, v8, v170
  v_mul_f32 v9, v9, v170
  v_mul_f32 v10, v10, v170
  v_mul_f32 v11, v11, v170
  v_mul_f32 v12, v12, v170
  v_mul_f32 v13, v13, v170
  v_mul_f32 v14, v14, v170
  v_mul_f32 v15, v15, v170
  v_mul_f32 v16, v16, v170
  v_mul_f32 v17, v17, v170
  v_mul_f32 v18, v18, v170
  v_mul_f32 v19, v19, v170
  v_mul_f32 v20, v20, v170
  v_mul_f32 v21, v21, v170
  v_mul_f32 v22, v22, v170
  v_mul_f32 v23, v23, v170
  v_mul_f32 v24, v24, v170
  v_mul_f32 v25, v25, v170
  v_mul_f32 v26, v26, v170
  v_mul_f32 v27, v27, v170
  v_mul_f32 v28, v28, v170
  v_mul_f32 v29, v29, v170
  v_mul_f32 v30, v30, v170
  v_mul_f32 v31, v31, v170
  v_mul_f32 v32, v32, v170
  v_mul_f32 v33, v33, v170
  v_mul_f32 v34, v34, v170
  v_mul_f32 v35, v35, v170
  v_mul_f32 v36, v36, v170
  v_mul_f32 v37, v37, v170
  v_mul_f32 v38, v38, v170
  v_mul_f32 v39, v39, v170
  v_mul_f32 v40, v40, v170
  v_mul_f32 v41, v41, v170
  v_mul_f32 v42, v42, v170
  v_mul_f32 v43, v43, v170
  v_mul_f32 v44, v44, v170
  v_mul_f32 v45, v45, v170
  v_mul_f32 v46, v46, v170
  v_mul_f32 v47, v47, v170
  v_mul_f32 v48, v48, v170
  v_mul_f32 v49, v49, v170
  v_mul_f32 v50, v50, v170
  v_mul_f32 v51, v51, v170
  v_mul_f32 v52, v52, v170
  v_mul_f32 v53, v53, v170
  v_mul_f32 v54, v54, v170
  v_mul_f32 v55, v55, v170
  v_mul_f32 v56, v56, v170
  v_mul_f32 v57, v57, v170
  v_mul_f32 v58, v58, v170
  v_mul_f32 v59, v59, v170
  v_mul_f32 v60, v60, v170
  v_mul_f32 v61, v61, v170
  v_mul_f32 v62, v62, v170
  v_mul_f32 v63, v63, v170
  v_mul_f32 v64, v64, v170
  v_mul_f32 v65, v65, v170
  v_mul_f32 v66, v66, v170
  v_mul_f32 v67, v67, v170
  v_mul_f32 v68, v68, v170
  v_mul_f32 v69, v69, v170
  v_mul_f32 v70, v70, v170
  v_mul_f32 v71, v71, v170
  v_mul_f32 v72, v72, v170
  v_mul_f32 v73, v73, v170
  v_mul_f32 v74, v74, v170
  v_mul_f32 v75, v75, v170
  v_mul_f32 v76, v76, v170
  v_mul_f32 v77, v77, v170
  v_mul_f32 v78, v78, v170
  v_mul_f32 v79, v79, v170
  v_mul_f32 v80, v80, v170
  v_mul_f32 v81, v81, v170
  v_mul_f32 v82, v82, v170
  v_mul_f32 v83, v83, v170
  v_mul_f32 v84, v84, v170
  v_mul_f32 v85, v85, v170
  v_mul_f32 v86, v86, v170
  v_mul_f32 v87, v87, v170
  v_mul_f32 v88, v88, v170
  v_mul_f32 v89, v89, v170
  v_mul_f32 v90, v90, v170
  v_mul_f32 v91, v91, v170
  v_mul_f32 v92, v92, v170
  v_mul_f32 v93, v93, v170
  v_mul_f32 v94, v94, v170
  v_mul_f32 v95, v95, v170
  v_mul_f32 v96, v96, v170
  v_mul_f32 v97, v97, v170
  v_mul_f32 v98, v98, v170
  v_mul_f32 v99, v99, v170
  v_mul_f32 v100, v100, v170
  v_mul_f32 v101, v101, v170
  v_mul_f32 v102, v102, v170
  v_mul_f32 v103, v103, v170
  ds_write_b32 v145, v4
  v_cvt_pk_bf16_f32 v12, v12, v13
  v_cvt_pk_bf16_f32 v13, v14, v15
  v_cvt_pk_bf16_f32 v16, v16, v17
  v_cvt_pk_bf16_f32 v17, v18, v19
  v_cvt_pk_bf16_f32 v20, v20, v21
  v_cvt_pk_bf16_f32 v21, v22, v23
  ds_write_b64 v140, v[12:13] offset:0
  ds_write_b64 v140, v[16:17] offset:3072
  ds_write_b64 v140, v[20:21] offset:6144
  v_cvt_pk_bf16_f32 v28, v28, v29
  v_cvt_pk_bf16_f32 v29, v30, v31
  v_cvt_pk_bf16_f32 v32, v32, v33
  v_cvt_pk_bf16_f32 v33, v34, v35
  v_cvt_pk_bf16_f32 v36, v36, v37
  v_cvt_pk_bf16_f32 v37, v38, v39
  ds_write_b64 v140, v[28:29] offset:512
  ds_write_b64 v140, v[32:33] offset:3584
  ds_write_b64 v140, v[36:37] offset:6656
  v_cvt_pk_bf16_f32 v44, v44, v45
  v_cvt_pk_bf16_f32 v45, v46, v47
  v_cvt_pk_bf16_f32 v48, v48, v49
  v_cvt_pk_bf16_f32 v49, v50, v51
  v_cvt_pk_bf16_f32 v52, v52, v53
  v_cvt_pk_bf16_f32 v53, v54, v55
  ds_write_b64 v140, v[44:45] offset:1024
  ds_write_b64 v140, v[48:49] offset:4096
  ds_write_b64 v140, v[52:53] offset:7168
  v_cvt_pk_bf16_f32 v60, v60, v61
  v_cvt_pk_bf16_f32 v61, v62, v63
  v_cvt_pk_bf16_f32 v64, v64, v65
  v_cvt_pk_bf16_f32 v65, v66, v67
  v_cvt_pk_bf16_f32 v68, v68, v69
  v_cvt_pk_bf16_f32 v69, v70, v71
  ds_write_b64 v140, v[60:61] offset:1536
  ds_write_b64 v140, v[64:65] offset:4608
  ds_write_b64 v140, v[68:69] offset:7680
  v_cvt_pk_bf16_f32 v76, v76, v77
  v_cvt_pk_bf16_f32 v77, v78, v79
  v_cvt_pk_bf16_f32 v80, v80, v81
  v_cvt_pk_bf16_f32 v81, v82, v83
  v_cvt_pk_bf16_f32 v84, v84, v85
  v_cvt_pk_bf16_f32 v85, v86, v87
  ds_write_b64 v140, v[76:77] offset:2048
  ds_write_b64 v140, v[80:81] offset:5120
  ds_write_b64 v140, v[84:85] offset:8192
  v_cvt_pk_bf16_f32 v92, v92, v93
  v_cvt_pk_bf16_f32 v93, v94, v95
  v_cvt_pk_bf16_f32 v96, v96, v97
  v_cvt_pk_bf16_f32 v97, v98, v99
  v_cvt_pk_bf16_f32 v100, v100, v101
  v_cvt_pk_bf16_f32 v101, v102, v103
  ds_write_b64 v140, v[92:93] offset:2560
  ds_write_b64 v140, v[96:97] offset:5632
  ds_write_b64 v140, v[100:101] offset:8704
  s_branch k2_tail
.section .rodata,"a"
.p2align 6
.amdhsa_kernel k1_kernel
  .amdhsa_next_free_vgpr 256
  .amdhsa_next_free_sgpr 102
  .amdhsa_accum_offset 256
  .amdhsa_group_segment_fixed_size 0
  .amdhsa_kernarg_size 64
  .amdhsa_user_sgpr_count 2
  .amdhsa_user_sgpr_kernarg_segment_ptr 1
  .amdhsa_system_sgpr_workgroup_id_x 1
.end_amdhsa_kernel

.section .rodata,"a"
.p2align 6
.amdhsa_kernel k2_kernel
  .amdhsa_next_free_vgpr 256
  .amdhsa_next_free_sgpr 102
  .amdhsa_accum_offset 256
  .amdhsa_group_segment_fixed_size 0
  .amdhsa_kernarg_size 64
  .amdhsa_user_sgpr_count 2
  .amdhsa_user_sgpr_kernarg_segment_ptr 1
  .amdhsa_system_sgpr_workgroup_id_x 1
.end_amdhsa_kernel
```
